```python
import torch

def _softmax(x, axis=-1):
    return torch.softmax(x, dim=axis)
def _gelu(x):
    return torch.nn.functional.gelu(x, approximate="tanh")
def _silu(x):
    return torch.nn.functional.silu(x)
def _sigmoid(x):
    return torch.sigmoid(x)
def _layernorm(x, axis=-1, eps=1e-5):
    m = x.mean(dim=axis, keepdim=True)
    v = x.var(dim=axis, keepdim=True, unbiased=False)
    return (x - m) / torch.sqrt(v + eps)
def _scatter_add(tgt, idx, src, axis=0):
    return tgt.clone().index_add_(axis, idx, src)
def _segment_sum(src, seg, n):
    out = torch.zeros((n,) + src.shape[1:], dtype=src.dtype)
    return out.index_add_(0, seg, src)
def _pad(x, pw):
    flat = tuple(v for pair in reversed(pw) for v in pair)
    return torch.nn.functional.pad(x, flat)

kernel_name = 'standalone__cross_network_dcn__recsys'

def setup_inputs():

    _w = (lambda a: (lambda t: t.to(torch.bfloat16) if t.is_floating_point() else t)(torch.as_tensor(a)))
    B, F, D, L = 16384, 26, 16, 6
    Din = min(F * D, 1024)
    return {
        "x0": _w((lambda *s: torch.randn(*s, dtype=torch.bfloat16) * 0.05)(B, Din)),
        "ws": _w((lambda *s: torch.randn(*s, dtype=torch.bfloat16) * 0.8)(L, Din, Din) * (Din ** -0.5)),
        "bs": _w((lambda *s: torch.randn(*s, dtype=torch.bfloat16) * 3.2)(L, Din) * 0.01),
    }

def reference(x0, ws, bs):
    x = x0
    L = ws.shape[0]
    for l in range(L):
        proj = torch.einsum('bd,de->be', x, ws[l]) + bs[l]
        x = x0 * proj + x
    return x
```

```asm
; @launch kernel=dcn_pre_kernel grid=(78,1,1) block=(512,1,1) lds=26624
; @launch kernel=standalone__cross_network_dcn__recsys_kernel grid=(256,1,1) block=(512,1,1) lds=120832
.amdgcn_target "amdgcn-amd-amdhsa--gfx950"
.text
.globl dcn_pre_kernel
.p2align 8
.type dcn_pre_kernel,@function
dcn_pre_kernel:
    s_cmp_ge_u32 s2, 78
    s_cbranch_scc1 L_pdone
    s_load_dwordx2 s[4:5], s[0:1], 8
    s_load_dwordx2 s[6:7], s[0:1], 40
    v_lshrrev_b32 v1, 6, v0
    v_and_b32 v2, 63, v0
    v_readfirstlane_b32 s12, v1
    s_mul_i32 s13, s2, 26624
    s_waitcnt lgkmcnt(0)
    s_add_u32 s8, s4, s13
    s_addc_u32 s9, s5, 0
    s_and_b32 s9, s9, 0xffff
    s_mov_b32 s10, 26624
    s_mov_b32 s11, 0x20000
    s_add_u32 s16, s6, s13
    s_addc_u32 s17, s7, 0
    s_and_b32 s17, s17, 0xffff
    s_mov_b32 s18, 26624
    s_mov_b32 s19, 0x20000
    s_movk_i32 s40, 1261
    s_add_u32 s14, s12, 0
    s_lshl_b32 s15, s14, 6
    v_add_u32 v3, s15, v2
    v_mul_lo_u32 v4, v3, s40
    v_lshrrev_b32 v4, 16, v4
    v_mul_u32_u24 v5, 52, v4
    v_sub_u32 v5, v3, v5
    v_bfe_u32 v6, v4, 3, 1
    v_lshlrev_b32 v6, 1, v6
    v_xor_b32 v5, v5, v6
    v_mul_u32_u24 v4, 832, v4
    v_lshl_add_u32 v4, v5, 4, v4
    s_lshl_b32 m0, s14, 10
    s_nop 0
    buffer_load_dwordx4 v4, s[8:11], 0 offen nt lds
    s_add_u32 s14, s12, 8
    s_lshl_b32 s15, s14, 6
    v_add_u32 v3, s15, v2
    v_mul_lo_u32 v4, v3, s40
    v_lshrrev_b32 v4, 16, v4
    v_mul_u32_u24 v5, 52, v4
    v_sub_u32 v5, v3, v5
    v_bfe_u32 v6, v4, 3, 1
    v_lshlrev_b32 v6, 1, v6
    v_xor_b32 v5, v5, v6
    v_mul_u32_u24 v4, 832, v4
    v_lshl_add_u32 v4, v5, 4, v4
    s_lshl_b32 m0, s14, 10
    s_nop 0
    buffer_load_dwordx4 v4, s[8:11], 0 offen nt lds
    s_add_u32 s14, s12, 16
    s_lshl_b32 s15, s14, 6
    v_add_u32 v3, s15, v2
    v_mul_lo_u32 v4, v3, s40
    v_lshrrev_b32 v4, 16, v4
    v_mul_u32_u24 v5, 52, v4
    v_sub_u32 v5, v3, v5
    v_bfe_u32 v6, v4, 3, 1
    v_lshlrev_b32 v6, 1, v6
    v_xor_b32 v5, v5, v6
    v_mul_u32_u24 v4, 832, v4
    v_lshl_add_u32 v4, v5, 4, v4
    s_lshl_b32 m0, s14, 10
    s_nop 0
    buffer_load_dwordx4 v4, s[8:11], 0 offen nt lds
    s_add_u32 s14, s12, 24
    s_lshl_b32 s15, s14, 6
    v_add_u32 v3, s15, v2
    v_mul_lo_u32 v4, v3, s40
    v_lshrrev_b32 v4, 16, v4
    v_mul_u32_u24 v5, 52, v4
    v_sub_u32 v5, v3, v5
    v_bfe_u32 v6, v4, 3, 1
    v_lshlrev_b32 v6, 1, v6
    v_xor_b32 v5, v5, v6
    v_mul_u32_u24 v4, 832, v4
    v_lshl_add_u32 v4, v5, 4, v4
    s_lshl_b32 m0, s14, 10
    s_cmp_lt_u32 s12, 2
    s_cbranch_scc0 L_p3
    buffer_load_dwordx4 v4, s[8:11], 0 offen nt lds
L_p3:
    v_lshrrev_b32 v10, 4, v2
    v_bfe_u32 v11, v2, 2, 2
    v_and_b32 v12, 3, v2
    v_lshl_add_u32 v13, v10, 3, v11
    v_mul_u32_u24 v13, 832, v13
    v_lshl_add_u32 v13, v12, 3, v13
    v_and_b32 v14, 1, v10
    v_lshlrev_b32 v15, 4, v2
    s_waitcnt vmcnt(0)
    s_barrier
    s_add_u32 s14, s12, 0
    v_xor_b32 v16, s14, v14
    v_lshl_add_u32 v16, v16, 5, v13
    ds_read_b64_tr_b16 v[20:21], v16
    ds_read_b64_tr_b16 v[22:23], v16 offset:3328
    s_lshl_b32 s15, s14, 10
    s_waitcnt lgkmcnt(0)
    buffer_store_dwordx4 v[20:23], v15, s[16:19], s15 offen
    s_add_u32 s14, s12, 8
    v_xor_b32 v16, s14, v14
    v_lshl_add_u32 v16, v16, 5, v13
    ds_read_b64_tr_b16 v[24:25], v16
    ds_read_b64_tr_b16 v[26:27], v16 offset:3328
    s_lshl_b32 s15, s14, 10
    s_waitcnt lgkmcnt(0)
    buffer_store_dwordx4 v[24:27], v15, s[16:19], s15 offen
    s_add_u32 s14, s12, 16
    v_xor_b32 v16, s14, v14
    v_lshl_add_u32 v16, v16, 5, v13
    ds_read_b64_tr_b16 v[28:29], v16
    ds_read_b64_tr_b16 v[30:31], v16 offset:3328
    s_lshl_b32 s15, s14, 10
    s_waitcnt lgkmcnt(0)
    buffer_store_dwordx4 v[28:31], v15, s[16:19], s15 offen
    s_add_u32 s14, s12, 24
    v_xor_b32 v16, s14, v14
    v_lshl_add_u32 v16, v16, 5, v13
    s_cmp_lt_u32 s12, 2
    s_cbranch_scc0 L_pdone
    ds_read_b64_tr_b16 v[32:33], v16
    ds_read_b64_tr_b16 v[34:35], v16 offset:3328
    s_lshl_b32 s15, s14, 10
    s_waitcnt lgkmcnt(0)
    buffer_store_dwordx4 v[32:35], v15, s[16:19], s15 offen
L_pdone:
s_endpgm
.globl standalone__cross_network_dcn__recsys_kernel
.p2align 8
.type standalone__cross_network_dcn__recsys_kernel,@function
standalone__cross_network_dcn__recsys_kernel:
    s_cmp_ge_u32 s2, 256
    s_cbranch_scc1 L_done
    s_load_dwordx2 s[4:5], s[0:1], 0
    s_load_dwordx4 s[32:35], s[0:1], 16
    s_load_dwordx2 s[6:7], s[0:1], 40
    v_lshrrev_b32 v48, 6, v0
    v_and_b32 v49, 63, v0
    v_readfirstlane_b32 s24, v48
    s_mul_i32 s29, s2, 53248
    s_mov_b32 s36, -1
    s_mov_b32 s37, 0xfffff
    v_lshlrev_b32 v50, 4, v49
    s_and_b32 s40, s24, 1
    s_lshl_b32 s40, s40, 4
    v_xor_b32 v51, s40, v50
    s_mul_i32 s38, s24, 3328
    s_mul_i32 s39, s24, 3456
    s_waitcnt lgkmcnt(0)
    s_add_u32 s12, s4, s29
    s_addc_u32 s13, s5, 0
    s_and_b32 s13, s13, 0xffff
    s_mov_b32 s14, 53248
    s_mov_b32 s15, 0x20000
    s_mov_b32 m0, s39
    s_mov_b64 exec, s[36:37]
    buffer_load_dwordx4 v51, s[12:15], s38 offen nt lds
    s_mov_b64 exec, -1
    s_add_u32 s39, s39, 864
    s_add_u32 s38, s38, 832
    s_mov_b32 m0, s39
    s_mov_b64 exec, s[36:37]
    buffer_load_dwordx4 v51, s[12:15], s38 offen nt lds
    s_mov_b64 exec, -1
    s_add_u32 s39, s39, 864
    s_add_u32 s38, s38, 832
    s_mov_b32 m0, s39
    s_mov_b64 exec, s[36:37]
    buffer_load_dwordx4 v51, s[12:15], s38 offen nt lds
    s_mov_b64 exec, -1
    s_add_u32 s39, s39, 864
    s_add_u32 s38, s38, 832
    s_mov_b32 m0, s39
    s_mov_b64 exec, s[36:37]
    buffer_load_dwordx4 v51, s[12:15], s38 offen nt lds
    s_mov_b64 exec, -1
    s_add_u32 s39, s39, 864
    s_add_u32 s38, s38, 832
    s_add_u32 s38, s38, 23296
    s_add_u32 s39, s39, 24192
    s_mov_b32 s8, s6
    s_and_b32 s9, s7, 0xffff
    s_mov_b32 s10, 2076672
    s_mov_b32 s11, 0x20000
    s_lshl_b32 s46, s24, 2
    s_mul_i32 s47, s24, 3
    s_add_u32 s47, s47, 2
    s_cmp_lt_u32 s24, 2
    s_cselect_b32 s46, s46, s47
    s_cselect_b32 s45, 0, 1
    s_lshl_b32 s27, s46, 10
    v_add_u32 v1, s27, v50
    s_mov_b32 s25, 0
    v_mov_b32 v26, v51
    v_mov_b32 v25, v50
    s_add_u32 s16, s34, s29
    s_addc_u32 s17, s35, 0
    s_and_b32 s17, s17, 0xffff
    s_mov_b32 s18, 53248
    s_mov_b32 s19, 0x20000
    s_mov_b32 s20, s32
    s_and_b32 s21, s33, 0xffff
    s_mov_b32 s22, 4992
    s_mov_b32 s23, 0x20000
    s_lshl_b32 s29, s46, 5
    v_lshrrev_b32 v52, 4, v49
    v_lshrrev_b32 v55, 1, v52
    v_and_b32 v56, 1, v52
    v_and_b32 v53, 15, v49
    v_bfe_u32 v54, v53, 2, 1
    v_mul_u32_u24 v57, 864, v53
    v_xor_b32 v58, v52, v54
    v_lshl_add_u32 v3, v58, 4, v57
    v_add_u32 v57, s29, v57
    v_xor_b32 v58, v55, v54
    v_lshl_add_u32 v57, v58, 4, v57
    v_lshl_add_u32 v4, v56, 5, v57
    v_mul_u32_u24 v58, 13824, v56
    v_add_u32 v5, v57, v58
    v_add_u32 v5, 64, v5
    v_lshl_add_u32 v7, v56, 3, v57
    v_lshlrev_b32 v52, 3, v52
    s_add_u32 s50, s29, 57344
    v_add_u32 v6, s50, v52
    s_mov_b32 s28, 0
    s_mov_b32 s43, 832
    s_mov_b32 s52, 0
    s_lshr_b32 s41, s2, 3
    s_and_b32 s41, s41, 31
    s_mul_i32 s57, s41, 10816
    s_add_u32 s57, s57, 296960
    s_mul_i32 s41, s41, 64896
    v_lshlrev_b32 v24, 7, v0
    s_cmp_eq_u32 s45, 1
    s_cbranch_scc1 L_start3
L_start4:
    buffer_load_dwordx4 a[0:3], v1, s[8:11], s25 offen offset:0
    buffer_load_dwordx4 a[4:7], v1, s[8:11], s25 offen offset:1024
    buffer_load_dwordx4 a[8:11], v1, s[8:11], s25 offen offset:2048
    buffer_load_dwordx4 a[12:15], v1, s[8:11], s25 offen offset:3072
    s_add_u32 s25, s25, 26624
    s_mov_b32 m0, s39
    s_mov_b64 exec, s[36:37]
    buffer_load_dwordx4 v26, s[12:15], s38 offen nt lds
    s_mov_b64 exec, -1
    s_add_u32 s39, s39, 864
    s_add_u32 s38, s38, 832
    s_mov_b32 m0, s39
    s_mov_b64 exec, s[36:37]
    buffer_load_dwordx4 v26, s[12:15], s38 offen nt lds
    s_mov_b64 exec, -1
    s_add_u32 s39, s39, 864
    s_add_u32 s38, s38, 832
    s_mov_b32 m0, s39
    s_mov_b64 exec, s[36:37]
    buffer_load_dwordx4 v26, s[12:15], s38 offen nt lds
    s_mov_b64 exec, -1
    s_add_u32 s39, s39, 864
    s_add_u32 s38, s38, 832
    s_mov_b32 m0, s39
    s_mov_b64 exec, s[36:37]
    buffer_load_dwordx4 v26, s[12:15], s38 offen nt lds
    s_mov_b64 exec, -1
    s_add_u32 s39, s39, 864
    s_add_u32 s38, s38, 832
    buffer_load_dwordx4 a[16:19], v1, s[8:11], s25 offen offset:0
    buffer_load_dwordx4 a[20:23], v1, s[8:11], s25 offen offset:1024
    buffer_load_dwordx4 a[24:27], v1, s[8:11], s25 offen offset:2048
    buffer_load_dwordx4 a[28:31], v1, s[8:11], s25 offen offset:3072
    s_add_u32 s25, s25, 26624
    v_mov_b32 v60, 1.0
    v_mov_b32 v61, 1.0
    v_mov_b32 v62, 1.0
    v_mov_b32 v63, 1.0
    v_mov_b32 v64, 1.0
    v_mov_b32 v65, 1.0
    v_mov_b32 v66, 1.0
    v_mov_b32 v67, 1.0
    v_mov_b32 v68, 1.0
    v_mov_b32 v69, 1.0
    v_mov_b32 v70, 1.0
    v_mov_b32 v71, 1.0
    v_mov_b32 v72, 1.0
    v_mov_b32 v73, 1.0
    v_mov_b32 v74, 1.0
    v_mov_b32 v75, 1.0
    v_mov_b32 v76, 1.0
    v_mov_b32 v77, 1.0
    v_mov_b32 v78, 1.0
    v_mov_b32 v79, 1.0
    v_mov_b32 v80, 1.0
    v_mov_b32 v81, 1.0
    v_mov_b32 v82, 1.0
    v_mov_b32 v83, 1.0
    v_mov_b32 v84, 1.0
    v_mov_b32 v85, 1.0
    v_mov_b32 v86, 1.0
    v_mov_b32 v87, 1.0
    v_mov_b32 v88, 1.0
    v_mov_b32 v89, 1.0
    v_mov_b32 v90, 1.0
    v_mov_b32 v91, 1.0
    v_mov_b32 v92, 1.0
    v_mov_b32 v93, 1.0
    v_mov_b32 v94, 1.0
    v_mov_b32 v95, 1.0
    v_mov_b32 v96, 1.0
    v_mov_b32 v97, 1.0
    v_mov_b32 v98, 1.0
    v_mov_b32 v99, 1.0
    v_mov_b32 v100, 1.0
    v_mov_b32 v101, 1.0
    v_mov_b32 v102, 1.0
    v_mov_b32 v103, 1.0
    v_mov_b32 v104, 1.0
    v_mov_b32 v105, 1.0
    v_mov_b32 v106, 1.0
    v_mov_b32 v107, 1.0
    v_mov_b32 v108, 1.0
    v_mov_b32 v109, 1.0
    v_mov_b32 v110, 1.0
    v_mov_b32 v111, 1.0
    v_mov_b32 v112, 1.0
    v_mov_b32 v113, 1.0
    v_mov_b32 v114, 1.0
    v_mov_b32 v115, 1.0
    v_mov_b32 v116, 1.0
    v_mov_b32 v117, 1.0
    v_mov_b32 v118, 1.0
    v_mov_b32 v119, 1.0
    v_mov_b32 v120, 1.0
    v_mov_b32 v121, 1.0
    v_mov_b32 v122, 1.0
    v_mov_b32 v123, 1.0
    s_waitcnt vmcnt(12)
    s_barrier
    ds_read_b128 a[112:115], v3 offset:0
    ds_read_b128 a[116:119], v3 offset:13824
    s_waitcnt vmcnt(8)
    s_waitcnt lgkmcnt(1)
    v_mfma_f32_16x16x32_bf16 v[60:63], a[0:3], a[112:115], v[60:63]
    buffer_load_dwordx4 a[32:35], v1, s[8:11], s25 offen offset:0
    buffer_load_dwordx4 a[36:39], v1, s[8:11], s25 offen offset:1024
    v_mfma_f32_16x16x32_bf16 v[64:67], a[4:7], a[112:115], v[64:67]
    buffer_load_dwordx4 a[40:43], v1, s[8:11], s25 offen offset:2048
    buffer_load_dwordx4 a[44:47], v1, s[8:11], s25 offen offset:3072
    v_mfma_f32_16x16x32_bf16 v[68:71], a[8:11], a[112:115], v[68:71]
    s_add_u32 s25, s25, 26624
    v_mfma_f32_16x16x32_bf16 v[72:75], a[12:15], a[112:115], v[72:75]
    ds_read_b128 a[112:115], v3 offset:64
    buffer_load_dwordx4 a[48:51], v1, s[8:11], s25 offen offset:0
    buffer_load_dwordx4 a[52:55], v1, s[8:11], s25 offen offset:1024
    s_waitcnt lgkmcnt(1)
    v_mfma_f32_16x16x32_bf16 v[76:79], a[0:3], a[116:119], v[76:79]
    buffer_load_dwordx4 a[56:59], v1, s[8:11], s25 offen offset:2048
    buffer_load_dwordx4 a[60:63], v1, s[8:11], s25 offen offset:3072
    v_mfma_f32_16x16x32_bf16 v[80:83], a[4:7], a[116:119], v[80:83]
    s_add_u32 s25, s25, 26624
    v_mfma_f32_16x16x32_bf16 v[84:87], a[8:11], a[116:119], v[84:87]
    v_mfma_f32_16x16x32_bf16 v[88:91], a[12:15], a[116:119], v[88:91]
    ds_read_b128 a[116:119], v3 offset:13888
    s_waitcnt vmcnt(8)
    s_waitcnt lgkmcnt(1)
    v_mfma_f32_16x16x32_bf16 v[60:63], a[16:19], a[112:115], v[60:63]
    buffer_load_dwordx4 a[64:67], v1, s[8:11], s25 offen offset:0
    v_mfma_f32_16x16x32_bf16 v[64:67], a[20:23], a[112:115], v[64:67]
    buffer_load_dwordx4 a[68:71], v1, s[8:11], s25 offen offset:1024
    v_mfma_f32_16x16x32_bf16 v[68:71], a[24:27], a[112:115], v[68:71]
    buffer_load_dwordx4 a[72:75], v1, s[8:11], s25 offen offset:2048
    v_mfma_f32_16x16x32_bf16 v[72:75], a[28:31], a[112:115], v[72:75]
    ds_read_b128 a[112:115], v3 offset:128
    buffer_load_dwordx4 a[76:79], v1, s[8:11], s25 offen offset:3072
    s_waitcnt lgkmcnt(1)
    v_mfma_f32_16x16x32_bf16 v[76:79], a[16:19], a[116:119], v[76:79]
    s_add_u32 s25, s25, 26624
    v_mfma_f32_16x16x32_bf16 v[80:83], a[20:23], a[116:119], v[80:83]
    v_mfma_f32_16x16x32_bf16 v[84:87], a[24:27], a[116:119], v[84:87]
    v_mfma_f32_16x16x32_bf16 v[88:91], a[28:31], a[116:119], v[88:91]
    ds_read_b128 a[116:119], v3 offset:13952
    s_waitcnt vmcnt(8) lgkmcnt(0)
    s_barrier
    v_mfma_f32_16x16x32_bf16 v[60:63], a[32:35], a[112:115], v[60:63]
    ds_read_b128 a[120:123], v3 offset:27648
    v_mfma_f32_16x16x32_bf16 v[64:67], a[36:39], a[112:115], v[64:67]
    v_mfma_f32_16x16x32_bf16 v[68:71], a[40:43], a[112:115], v[68:71]
    v_mfma_f32_16x16x32_bf16 v[72:75], a[44:47], a[112:115], v[72:75]
    ds_read_b128 a[112:115], v3 offset:192
    ds_read_b128 a[124:127], v3 offset:41472
    v_mfma_f32_16x16x32_bf16 v[76:79], a[32:35], a[116:119], v[76:79]
    v_mfma_f32_16x16x32_bf16 v[80:83], a[36:39], a[116:119], v[80:83]
    v_mfma_f32_16x16x32_bf16 v[84:87], a[40:43], a[116:119], v[84:87]
    v_mfma_f32_16x16x32_bf16 v[88:91], a[44:47], a[116:119], v[88:91]
    ds_read_b128 a[116:119], v3 offset:14016
    s_branch L_sS_4
.p2align 6
L_layer4:
    s_waitcnt vmcnt(12)
    v_mfma_f32_16x16x32_bf16 v[60:63], a[0:3], a[112:115], v[60:63]
    v_mfma_f32_16x16x32_bf16 v[64:67], a[4:7], a[112:115], v[64:67]
    v_mfma_f32_16x16x32_bf16 v[68:71], a[8:11], a[112:115], v[68:71]
    v_lshlrev_b32 v12, 16, v48
    v_and_b32 v13, 0xffff0000, v48
    v_lshlrev_b32 v14, 16, v49
    v_and_b32 v15, 0xffff0000, v49
    v_mfma_f32_16x16x32_bf16 v[72:75], a[12:15], a[112:115], v[72:75]
    ds_read_b128 a[112:115], v3 offset:64
    v_lshlrev_b32 v16, 16, v50
    v_and_b32 v17, 0xffff0000, v50
    v_lshlrev_b32 v18, 16, v51
    v_and_b32 v19, 0xffff0000, v51
    v_mfma_f32_16x16x32_bf16 v[76:79], a[0:3], a[116:119], v[76:79]
    v_mul_f32 v12, v100, v12
    v_mul_f32 v13, v101, v13
    v_mul_f32 v14, v102, v14
    v_mul_f32 v15, v103, v15
    v_mfma_f32_16x16x32_bf16 v[80:83], a[4:7], a[116:119], v[80:83]
    v_mul_f32 v16, v104, v16
    v_mul_f32 v17, v105, v17
    v_mul_f32 v18, v106, v18
    v_mul_f32 v19, v107, v19
    v_mfma_f32_16x16x32_bf16 v[84:87], a[8:11], a[116:119], v[84:87]
    v_cvt_pk_bf16_f32 v8, v12, v13
    v_cvt_pk_bf16_f32 v9, v14, v15
    v_cvt_pk_bf16_f32 v10, v16, v17
    v_cvt_pk_bf16_f32 v11, v18, v19
    v_mfma_f32_16x16x32_bf16 v[88:91], a[12:15], a[116:119], v[88:91]
    ds_read_b128 a[116:119], v3 offset:13888
    s_nop 1
    v_permlane16_swap_b32 v8, v10
    v_permlane16_swap_b32 v9, v11
    ds_write_b128 v4, v[8:11] offset:27712
    s_waitcnt vmcnt(8)
    s_waitcnt lgkmcnt(2)
    v_mfma_f32_16x16x32_bf16 v[60:63], a[16:19], a[112:115], v[60:63]
    buffer_load_dwordx4 a[64:67], v1, s[8:11], s25 offen offset:0
    v_mfma_f32_16x16x32_bf16 v[64:67], a[20:23], a[112:115], v[64:67]
    buffer_load_dwordx4 a[68:71], v1, s[8:11], s25 offen offset:1024
    v_mfma_f32_16x16x32_bf16 v[68:71], a[24:27], a[112:115], v[68:71]
    buffer_load_dwordx4 a[72:75], v1, s[8:11], s25 offen offset:2048
    v_lshlrev_b32 v12, 16, v52
    v_and_b32 v13, 0xffff0000, v52
    v_lshlrev_b32 v14, 16, v53
    v_and_b32 v15, 0xffff0000, v53
    v_lshlrev_b32 v16, 16, v54
    v_and_b32 v17, 0xffff0000, v54
    v_lshlrev_b32 v18, 16, v55
    v_and_b32 v19, 0xffff0000, v55
    v_mfma_f32_16x16x32_bf16 v[72:75], a[28:31], a[112:115], v[72:75]
    ds_read_b128 a[112:115], v3 offset:128
    buffer_load_dwordx4 a[76:79], v1, s[8:11], s25 offen offset:3072
    v_mul_f32 v12, v108, v12
    v_mul_f32 v13, v109, v13
    v_mul_f32 v14, v110, v14
    v_mul_f32 v15, v111, v15
    v_mul_f32 v16, v112, v16
    v_mul_f32 v17, v113, v17
    v_mul_f32 v18, v114, v18
    v_mul_f32 v19, v115, v19
    s_waitcnt lgkmcnt(2)
    v_mfma_f32_16x16x32_bf16 v[76:79], a[16:19], a[116:119], v[76:79]
    s_add_u32 s25, s25, 26624
    v_cvt_pk_bf16_f32 v8, v12, v13
    v_cvt_pk_bf16_f32 v9, v14, v15
    v_cvt_pk_bf16_f32 v10, v16, v17
    v_cvt_pk_bf16_f32 v11, v18, v19
    s_nop 1
    v_permlane16_swap_b32 v8, v10
    v_permlane16_swap_b32 v9, v11
    ds_write_b128 v4, v[8:11] offset:41472
    v_lshlrev_b32 v12, 16, v56
    v_mfma_f32_16x16x32_bf16 v[80:83], a[20:23], a[116:119], v[80:83]
    v_and_b32 v13, 0xffff0000, v56
    v_lshlrev_b32 v14, 16, v57
    v_and_b32 v15, 0xffff0000, v57
    v_lshlrev_b32 v16, 16, v58
    v_and_b32 v17, 0xffff0000, v58
    v_lshlrev_b32 v18, 16, v59
    v_and_b32 v19, 0xffff0000, v59
    v_mul_f32 v12, v116, v12
    v_mfma_f32_16x16x32_bf16 v[84:87], a[24:27], a[116:119], v[84:87]
    v_mul_f32 v13, v117, v13
    v_mul_f32 v14, v118, v14
    v_mul_f32 v15, v119, v15
    v_mul_f32 v16, v120, v16
    v_mul_f32 v17, v121, v17
    v_mul_f32 v18, v122, v18
    v_mul_f32 v19, v123, v19
    v_mfma_f32_16x16x32_bf16 v[88:91], a[28:31], a[116:119], v[88:91]
    ds_read_b128 a[116:119], v3 offset:13952
    v_cvt_pk_bf16_f32 v8, v12, v13
    v_cvt_pk_bf16_f32 v9, v14, v15
    v_cvt_pk_bf16_f32 v10, v16, v17
    v_cvt_pk_bf16_f32 v11, v18, v19
    s_nop 1
    v_permlane16_swap_b32 v8, v10
    v_permlane16_swap_b32 v9, v11
    ds_write_b128 v4, v[8:11] offset:41536
    s_waitcnt vmcnt(8) lgkmcnt(0)
    s_barrier
    v_mfma_f32_16x16x32_bf16 v[60:63], a[32:35], a[112:115], v[60:63]
    ds_read_b128 a[120:123], v3 offset:27648
    v_mfma_f32_16x16x32_bf16 v[64:67], a[36:39], a[112:115], v[64:67]
    v_mfma_f32_16x16x32_bf16 v[68:71], a[40:43], a[112:115], v[68:71]
    v_mfma_f32_16x16x32_bf16 v[72:75], a[44:47], a[112:115], v[72:75]
    ds_read_b128 a[112:115], v3 offset:192
    ds_read_b128 a[124:127], v3 offset:41472
    v_mfma_f32_16x16x32_bf16 v[76:79], a[32:35], a[116:119], v[76:79]
    v_mfma_f32_16x16x32_bf16 v[80:83], a[36:39], a[116:119], v[80:83]
    v_mfma_f32_16x16x32_bf16 v[84:87], a[40:43], a[116:119], v[84:87]
    v_mfma_f32_16x16x32_bf16 v[88:91], a[44:47], a[116:119], v[88:91]
    ds_read_b128 a[116:119], v3 offset:14016
L_sS_4:
    s_waitcnt vmcnt(4)
    v_mfma_f32_16x16x32_bf16 v[60:63], a[48:51], a[112:115], v[60:63]
    buffer_load_dwordx4 a[80:83], v1, s[8:11], s25 offen offset:0
    v_mfma_f32_16x16x32_bf16 v[64:67], a[52:55], a[112:115], v[64:67]
    buffer_load_dwordx4 a[84:87], v1, s[8:11], s25 offen offset:1024
    v_mfma_f32_16x16x32_bf16 v[68:71], a[56:59], a[112:115], v[68:71]
    buffer_load_dwordx4 a[88:91], v1, s[8:11], s25 offen offset:2048
    v_mfma_f32_16x16x32_bf16 v[72:75], a[60:63], a[112:115], v[72:75]
    ds_read_b128 a[112:115], v3 offset:256
    v_mfma_f32_16x16x32_bf16 v[76:79], a[48:51], a[116:119], v[76:79]
    buffer_load_dwordx4 a[92:95], v1, s[8:11], s25 offen offset:3072
    v_mfma_f32_16x16x32_bf16 v[80:83], a[52:55], a[116:119], v[80:83]
    s_add_u32 s25, s25, 26624
    v_mfma_f32_16x16x32_bf16 v[84:87], a[56:59], a[116:119], v[84:87]
    ds_read_b64 v[20:21], v6 offset:0
    v_mfma_f32_16x16x32_bf16 v[88:91], a[60:63], a[116:119], v[88:91]
    ds_read_b128 a[116:119], v3 offset:14080
    v_mfma_f32_16x16x32_bf16 v[92:95], a[0:3], a[120:123], v[92:95]
    s_cmp_eq_u32 s28, 0
    s_cbranch_scc0 L_cv11
    ds_read_b64 v[28:29], v7 offset:0
    ds_read_b64 v[30:31], v7 offset:32
    ds_read_b64 v[32:33], v7 offset:64
    ds_read_b64 v[34:35], v7 offset:96
L_cv11:
    ds_read_b64 v[22:23], v6 offset:32
    v_mfma_f32_16x16x32_bf16 v[96:99], a[4:7], a[120:123], v[96:99]
    ds_read_b64 v[24:25], v6 offset:64
    v_mfma_f32_16x16x32_bf16 v[100:103], a[8:11], a[120:123], v[100:103]
    ds_read_b64 v[26:27], v6 offset:96
    v_mfma_f32_16x16x32_bf16 v[104:107], a[12:15], a[120:123], v[104:107]
    ds_read_b128 a[120:123], v3 offset:27712
    v_mfma_f32_16x16x32_bf16 v[108:111], a[0:3], a[124:127], v[108:111]
    v_mfma_f32_16x16x32_bf16 v[112:115], a[4:7], a[124:127], v[112:115]
    v_mfma_f32_16x16x32_bf16 v[116:119], a[8:11], a[124:127], v[116:119]
    v_mfma_f32_16x16x32_bf16 v[120:123], a[12:15], a[124:127], v[120:123]
    ds_read_b128 a[124:127], v3 offset:41536
    s_waitcnt vmcnt(4)
    s_waitcnt lgkmcnt(7)
    v_mfma_f32_16x16x32_bf16 v[60:63], a[64:67], a[112:115], v[60:63]
    s_waitcnt lgkmcnt(6)
    v_lshlrev_b32 v8, 16, v20
    v_and_b32 v9, 0xffff0000, v20
    v_lshlrev_b32 v10, 16, v21
    v_and_b32 v11, 0xffff0000, v21
    v_xor_b32 v4, 65536, v4
    v_mfma_f32_16x16x32_bf16 v[64:67], a[68:71], a[112:115], v[64:67]
    v_add_f32 v108, v8, v108
    v_add_f32 v109, v9, v109
    v_xor_b32 v5, 65536, v5
    v_mfma_f32_16x16x32_bf16 v[68:71], a[72:75], a[112:115], v[68:71]
    v_add_f32 v110, v10, v110
    v_add_f32 v111, v11, v111
    v_mfma_f32_16x16x32_bf16 v[72:75], a[76:79], a[112:115], v[72:75]
    ds_read_b128 a[112:115], v3 offset:320
    buffer_load_dwordx4 a[0:3], v1, s[8:11], s25 offen offset:0
    s_waitcnt lgkmcnt(6)
    v_mfma_f32_16x16x32_bf16 v[76:79], a[64:67], a[116:119], v[76:79]
    v_mfma_f32_16x16x32_bf16 v[80:83], a[68:71], a[116:119], v[80:83]
    v_add_f32 v60, v8, v60
    v_add_f32 v61, v9, v61
    buffer_load_dwordx4 a[4:7], v1, s[8:11], s25 offen offset:1024
    v_mfma_f32_16x16x32_bf16 v[84:87], a[72:75], a[116:119], v[84:87]
    v_add_f32 v62, v10, v62
    v_add_f32 v63, v11, v63
    buffer_load_dwordx4 a[8:11], v1, s[8:11], s25 offen offset:2048
    v_mfma_f32_16x16x32_bf16 v[88:91], a[76:79], a[116:119], v[88:91]
    ds_read_b128 a[116:119], v3 offset:14144
    s_waitcnt lgkmcnt(3)
    v_mfma_f32_16x16x32_bf16 v[92:95], a[16:19], a[120:123], v[92:95]
    s_cmp_eq_u32 s28, 0
    s_cbranch_scc0 L_cv12
    ds_read_b64 v[36:37], v7 offset:13824
    ds_read_b64 v[38:39], v7 offset:13856
    ds_read_b64 v[40:41], v7 offset:13888
    ds_read_b64 v[42:43], v7 offset:13920
L_cv12:
    buffer_load_dwordx4 a[12:15], v1, s[8:11], s25 offen offset:3072
    v_mfma_f32_16x16x32_bf16 v[96:99], a[20:23], a[120:123], v[96:99]
    v_add_f32 v76, v8, v76
    v_add_f32 v77, v9, v77
    v_mfma_f32_16x16x32_bf16 v[100:103], a[24:27], a[120:123], v[100:103]
    v_add_f32 v78, v10, v78
    v_add_f32 v79, v11, v79
    s_add_u32 s25, s25, 26624
    v_mfma_f32_16x16x32_bf16 v[104:107], a[28:31], a[120:123], v[104:107]
    ds_read_b128 a[120:123], v3 offset:27776
    s_waitcnt lgkmcnt(3)
    v_mfma_f32_16x16x32_bf16 v[108:111], a[16:19], a[124:127], v[108:111]
    v_mfma_f32_16x16x32_bf16 v[112:115], a[20:23], a[124:127], v[112:115]
    v_add_f32 v92, v8, v92
    v_add_f32 v93, v9, v93
    v_mfma_f32_16x16x32_bf16 v[116:119], a[24:27], a[124:127], v[116:119]
    v_add_f32 v94, v10, v94
    v_add_f32 v95, v11, v95
    v_mfma_f32_16x16x32_bf16 v[120:123], a[28:31], a[124:127], v[120:123]
    ds_read_b128 a[124:127], v3 offset:41600
    s_waitcnt vmcnt(4)
    s_waitcnt lgkmcnt(3)
    v_mfma_f32_16x16x32_bf16 v[60:63], a[80:83], a[112:115], v[60:63]
    v_lshlrev_b32 v8, 16, v22
    v_and_b32 v9, 0xffff0000, v22
    v_lshlrev_b32 v10, 16, v23
    v_and_b32 v11, 0xffff0000, v23
    buffer_load_dwordx4 a[16:19], v1, s[8:11], s25 offen offset:0
    v_mfma_f32_16x16x32_bf16 v[64:67], a[84:87], a[112:115], v[64:67]
    v_mfma_f32_16x16x32_bf16 v[68:71], a[88:91], a[112:115], v[68:71]
    v_add_f32 v112, v8, v112
    v_add_f32 v113, v9, v113
    buffer_load_dwordx4 a[20:23], v1, s[8:11], s25 offen offset:1024
    v_mfma_f32_16x16x32_bf16 v[72:75], a[92:95], a[112:115], v[72:75]
    ds_read_b128 a[112:115], v3 offset:384
    v_add_f32 v114, v10, v114
    v_add_f32 v115, v11, v115
    s_waitcnt lgkmcnt(3)
    v_mfma_f32_16x16x32_bf16 v[76:79], a[80:83], a[116:119], v[76:79]
    buffer_load_dwordx4 a[24:27], v1, s[8:11], s25 offen offset:2048
    v_mfma_f32_16x16x32_bf16 v[80:83], a[84:87], a[116:119], v[80:83]
    v_mfma_f32_16x16x32_bf16 v[84:87], a[88:91], a[116:119], v[84:87]
    v_add_f32 v64, v8, v64
    v_add_f32 v65, v9, v65
    v_mfma_f32_16x16x32_bf16 v[88:91], a[92:95], a[116:119], v[88:91]
    ds_read_b128 a[116:119], v3 offset:14208
    v_add_f32 v66, v10, v66
    v_add_f32 v67, v11, v67
    buffer_load_dwordx4 a[28:31], v1, s[8:11], s25 offen offset:3072
    s_waitcnt lgkmcnt(3)
    v_mfma_f32_16x16x32_bf16 v[92:95], a[32:35], a[120:123], v[92:95]
    s_cmp_eq_u32 s28, 0
    s_cbranch_scc0 L_cv13
    ds_read_b64 v[44:45], v7 offset:27648
    ds_read_b64 v[46:47], v7 offset:27680
    ds_read_b64 v[48:49], v7 offset:27712
    ds_read_b64 v[50:51], v7 offset:27744
L_cv13:
    v_mfma_f32_16x16x32_bf16 v[96:99], a[36:39], a[120:123], v[96:99]
    s_add_u32 s25, s25, 26624
    v_mfma_f32_16x16x32_bf16 v[100:103], a[40:43], a[120:123], v[100:103]
    v_add_f32 v80, v8, v80
    v_add_f32 v81, v9, v81
    v_mfma_f32_16x16x32_bf16 v[104:107], a[44:47], a[120:123], v[104:107]
    ds_read_b128 a[120:123], v3 offset:27840
    v_add_f32 v82, v10, v82
    v_add_f32 v83, v11, v83
    s_waitcnt lgkmcnt(3)
    v_mfma_f32_16x16x32_bf16 v[108:111], a[32:35], a[124:127], v[108:111]
    v_mfma_f32_16x16x32_bf16 v[112:115], a[36:39], a[124:127], v[112:115]
    v_mfma_f32_16x16x32_bf16 v[116:119], a[40:43], a[124:127], v[116:119]
    v_add_f32 v96, v8, v96
    v_add_f32 v97, v9, v97
    v_mfma_f32_16x16x32_bf16 v[120:123], a[44:47], a[124:127], v[120:123]
    ds_read_b128 a[124:127], v3 offset:41664
    v_add_f32 v98, v10, v98
    v_add_f32 v99, v11, v99
    s_waitcnt vmcnt(4)
    s_waitcnt lgkmcnt(3)
    v_mfma_f32_16x16x32_bf16 v[60:63], a[0:3], a[112:115], v[60:63]
    v_lshlrev_b32 v8, 16, v24
    v_and_b32 v9, 0xffff0000, v24
    v_lshlrev_b32 v10, 16, v25
    v_and_b32 v11, 0xffff0000, v25
    v_add_f32 v102, v10, v102
    v_add_f32 v103, v11, v103
    buffer_load_dwordx4 a[32:35], v1, s[8:11], s25 offen offset:0
    v_mfma_f32_16x16x32_bf16 v[64:67], a[4:7], a[112:115], v[64:67]
    v_mfma_f32_16x16x32_bf16 v[68:71], a[8:11], a[112:115], v[68:71]
    buffer_load_dwordx4 a[36:39], v1, s[8:11], s25 offen offset:1024
    v_mfma_f32_16x16x32_bf16 v[72:75], a[12:15], a[112:115], v[72:75]
    ds_read_b128 a[112:115], v3 offset:448
    v_add_f32 v116, v8, v116
    v_add_f32 v117, v9, v117
    s_waitcnt lgkmcnt(3)
    v_mfma_f32_16x16x32_bf16 v[76:79], a[0:3], a[116:119], v[76:79]
    v_add_f32 v118, v10, v118
    v_add_f32 v119, v11, v119
    buffer_load_dwordx4 a[40:43], v1, s[8:11], s25 offen offset:2048
    v_mfma_f32_16x16x32_bf16 v[80:83], a[4:7], a[116:119], v[80:83]
    v_mfma_f32_16x16x32_bf16 v[84:87], a[8:11], a[116:119], v[84:87]
    v_mfma_f32_16x16x32_bf16 v[88:91], a[12:15], a[116:119], v[88:91]
    ds_read_b128 a[116:119], v3 offset:14272
    v_add_f32 v68, v8, v68
    v_add_f32 v69, v9, v69
    buffer_load_dwordx4 a[44:47], v1, s[8:11], s25 offen offset:3072
    s_waitcnt lgkmcnt(3)
    v_mfma_f32_16x16x32_bf16 v[92:95], a[48:51], a[120:123], v[92:95]
    s_cmp_eq_u32 s28, 0
    s_cbranch_scc0 L_cv14
    ds_read_b64 v[52:53], v7 offset:41472
    ds_read_b64 v[54:55], v7 offset:41504
    ds_read_b64 v[56:57], v7 offset:41536
    ds_read_b64 v[58:59], v7 offset:41568
L_cv14:
    v_add_f32 v70, v10, v70
    v_add_f32 v71, v11, v71
    v_mfma_f32_16x16x32_bf16 v[96:99], a[52:55], a[120:123], v[96:99]
    s_add_u32 s25, s25, 26624
    v_mfma_f32_16x16x32_bf16 v[100:103], a[56:59], a[120:123], v[100:103]
    v_mfma_f32_16x16x32_bf16 v[104:107], a[60:63], a[120:123], v[104:107]
    ds_read_b128 a[120:123], v3 offset:27904
    v_add_f32 v84, v8, v84
    v_add_f32 v85, v9, v85
    s_waitcnt lgkmcnt(3)
    v_mfma_f32_16x16x32_bf16 v[108:111], a[48:51], a[124:127], v[108:111]
    v_add_f32 v86, v10, v86
    v_add_f32 v87, v11, v87
    v_mfma_f32_16x16x32_bf16 v[112:115], a[52:55], a[124:127], v[112:115]
    v_mfma_f32_16x16x32_bf16 v[116:119], a[56:59], a[124:127], v[116:119]
    v_mfma_f32_16x16x32_bf16 v[120:123], a[60:63], a[124:127], v[120:123]
    ds_read_b128 a[124:127], v3 offset:41728
    v_add_f32 v100, v8, v100
    v_add_f32 v101, v9, v101
    s_waitcnt vmcnt(4)
    s_waitcnt lgkmcnt(3)
    v_mfma_f32_16x16x32_bf16 v[60:63], a[16:19], a[112:115], v[60:63]
    v_lshlrev_b32 v8, 16, v26
    v_and_b32 v9, 0xffff0000, v26
    v_lshlrev_b32 v10, 16, v27
    v_and_b32 v11, 0xffff0000, v27
    v_add_f32 v104, v8, v104
    v_add_f32 v105, v9, v105
    buffer_load_dwordx4 a[48:51], v1, s[8:11], s25 offen offset:0
    v_mfma_f32_16x16x32_bf16 v[64:67], a[20:23], a[112:115], v[64:67]
    v_add_f32 v106, v10, v106
    v_add_f32 v107, v11, v107
    v_mfma_f32_16x16x32_bf16 v[68:71], a[24:27], a[112:115], v[68:71]
    buffer_load_dwordx4 a[52:55], v1, s[8:11], s25 offen offset:1024
    v_mfma_f32_16x16x32_bf16 v[72:75], a[28:31], a[112:115], v[72:75]
    ds_read_b128 a[112:115], v3 offset:512
    s_waitcnt lgkmcnt(3)
    v_mfma_f32_16x16x32_bf16 v[76:79], a[16:19], a[116:119], v[76:79]
    v_add_f32 v120, v8, v120
    v_add_f32 v121, v9, v121
    buffer_load_dwordx4 a[56:59], v1, s[8:11], s25 offen offset:2048
    v_mfma_f32_16x16x32_bf16 v[80:83], a[20:23], a[116:119], v[80:83]
    v_add_f32 v122, v10, v122
    v_add_f32 v123, v11, v123
    v_mfma_f32_16x16x32_bf16 v[84:87], a[24:27], a[116:119], v[84:87]
    v_mfma_f32_16x16x32_bf16 v[88:91], a[28:31], a[116:119], v[88:91]
    ds_read_b128 a[116:119], v3 offset:14336
    buffer_load_dwordx4 a[60:63], v1, s[8:11], s25 offen offset:3072
    s_waitcnt lgkmcnt(3)
    v_mfma_f32_16x16x32_bf16 v[92:95], a[64:67], a[120:123], v[92:95]
    v_add_f32 v72, v8, v72
    v_add_f32 v73, v9, v73
    v_mfma_f32_16x16x32_bf16 v[96:99], a[68:71], a[120:123], v[96:99]
    v_add_f32 v74, v10, v74
    v_add_f32 v75, v11, v75
    s_add_u32 s25, s25, 26624
    v_mfma_f32_16x16x32_bf16 v[100:103], a[72:75], a[120:123], v[100:103]
    v_mfma_f32_16x16x32_bf16 v[104:107], a[76:79], a[120:123], v[104:107]
    ds_read_b128 a[120:123], v3 offset:27968
    s_waitcnt lgkmcnt(3)
    v_mfma_f32_16x16x32_bf16 v[108:111], a[64:67], a[124:127], v[108:111]
    v_add_f32 v88, v8, v88
    v_add_f32 v89, v9, v89
    v_mfma_f32_16x16x32_bf16 v[112:115], a[68:71], a[124:127], v[112:115]
    v_add_f32 v90, v10, v90
    v_add_f32 v91, v11, v91
    v_mfma_f32_16x16x32_bf16 v[116:119], a[72:75], a[124:127], v[116:119]
    v_mfma_f32_16x16x32_bf16 v[120:123], a[76:79], a[124:127], v[120:123]
    ds_read_b128 a[124:127], v3 offset:41792
    s_waitcnt vmcnt(4)
    s_waitcnt lgkmcnt(3)
    v_mfma_f32_16x16x32_bf16 v[60:63], a[32:35], a[112:115], v[60:63]
    buffer_load_dwordx4 a[64:67], v1, s[8:11], s25 offen offset:0
    v_mfma_f32_16x16x32_bf16 v[64:67], a[36:39], a[112:115], v[64:67]
    v_mfma_f32_16x16x32_bf16 v[68:71], a[40:43], a[112:115], v[68:71]
    buffer_load_dwordx4 a[68:71], v1, s[8:11], s25 offen offset:1024
    v_mfma_f32_16x16x32_bf16 v[72:75], a[44:47], a[112:115], v[72:75]
    ds_read_b128 a[112:115], v3 offset:576
    s_waitcnt lgkmcnt(3)
    v_mfma_f32_16x16x32_bf16 v[76:79], a[32:35], a[116:119], v[76:79]
    buffer_load_dwordx4 a[72:75], v1, s[8:11], s25 offen offset:2048
    v_mfma_f32_16x16x32_bf16 v[80:83], a[36:39], a[116:119], v[80:83]
    v_mfma_f32_16x16x32_bf16 v[84:87], a[40:43], a[116:119], v[84:87]
    v_mfma_f32_16x16x32_bf16 v[88:91], a[44:47], a[116:119], v[88:91]
    ds_read_b128 a[116:119], v3 offset:14400
    buffer_load_dwordx4 a[76:79], v1, s[8:11], s25 offen offset:3072
    s_waitcnt lgkmcnt(3)
    v_mfma_f32_16x16x32_bf16 v[92:95], a[80:83], a[120:123], v[92:95]
    v_mfma_f32_16x16x32_bf16 v[96:99], a[84:87], a[120:123], v[96:99]
    s_add_u32 s25, s25, 26624
    v_mfma_f32_16x16x32_bf16 v[100:103], a[88:91], a[120:123], v[100:103]
    v_mfma_f32_16x16x32_bf16 v[104:107], a[92:95], a[120:123], v[104:107]
    ds_read_b128 a[120:123], v3 offset:28032
    s_waitcnt lgkmcnt(3)
    v_mfma_f32_16x16x32_bf16 v[108:111], a[80:83], a[124:127], v[108:111]
    v_mfma_f32_16x16x32_bf16 v[112:115], a[84:87], a[124:127], v[112:115]
    v_mfma_f32_16x16x32_bf16 v[116:119], a[88:91], a[124:127], v[116:119]
    v_mfma_f32_16x16x32_bf16 v[120:123], a[92:95], a[124:127], v[120:123]
    ds_read_b128 a[124:127], v3 offset:41856
    s_waitcnt vmcnt(4)
    s_waitcnt lgkmcnt(3)
    v_mfma_f32_16x16x32_bf16 v[60:63], a[48:51], a[112:115], v[60:63]
    buffer_load_dwordx4 a[80:83], v1, s[8:11], s25 offen offset:0
    v_mfma_f32_16x16x32_bf16 v[64:67], a[52:55], a[112:115], v[64:67]
    v_mfma_f32_16x16x32_bf16 v[68:71], a[56:59], a[112:115], v[68:71]
    buffer_load_dwordx4 a[84:87], v1, s[8:11], s25 offen offset:1024
    v_mfma_f32_16x16x32_bf16 v[72:75], a[60:63], a[112:115], v[72:75]
    ds_read_b128 a[112:115], v3 offset:640
    s_waitcnt lgkmcnt(3)
    v_mfma_f32_16x16x32_bf16 v[76:79], a[48:51], a[116:119], v[76:79]
    buffer_load_dwordx4 a[88:91], v1, s[8:11], s25 offen offset:2048
    v_mfma_f32_16x16x32_bf16 v[80:83], a[52:55], a[116:119], v[80:83]
    v_mfma_f32_16x16x32_bf16 v[84:87], a[56:59], a[116:119], v[84:87]
    v_mfma_f32_16x16x32_bf16 v[88:91], a[60:63], a[116:119], v[88:91]
    ds_read_b128 a[116:119], v3 offset:14464
    buffer_load_dwordx4 a[92:95], v1, s[8:11], s25 offen offset:3072
    s_waitcnt lgkmcnt(3)
    v_mfma_f32_16x16x32_bf16 v[92:95], a[0:3], a[120:123], v[92:95]
    v_mfma_f32_16x16x32_bf16 v[96:99], a[4:7], a[120:123], v[96:99]
    s_add_u32 s25, s25, 26624
    v_mfma_f32_16x16x32_bf16 v[100:103], a[8:11], a[120:123], v[100:103]
    v_mfma_f32_16x16x32_bf16 v[104:107], a[12:15], a[120:123], v[104:107]
    ds_read_b128 a[120:123], v3 offset:28096
    s_waitcnt lgkmcnt(3)
    v_mfma_f32_16x16x32_bf16 v[108:111], a[0:3], a[124:127], v[108:111]
    v_mfma_f32_16x16x32_bf16 v[112:115], a[4:7], a[124:127], v[112:115]
    v_mfma_f32_16x16x32_bf16 v[116:119], a[8:11], a[124:127], v[116:119]
    v_mfma_f32_16x16x32_bf16 v[120:123], a[12:15], a[124:127], v[120:123]
    ds_read_b128 a[124:127], v3 offset:41920
    s_waitcnt vmcnt(4)
    s_waitcnt lgkmcnt(3)
    v_mfma_f32_16x16x32_bf16 v[60:63], a[64:67], a[112:115], v[60:63]
    buffer_load_dwordx4 a[96:99], v1, s[8:11], s25 offen offset:0
    v_mfma_f32_16x16x32_bf16 v[64:67], a[68:71], a[112:115], v[64:67]
    buffer_load_dwordx4 a[100:103], v1, s[8:11], s25 offen offset:1024
    v_mfma_f32_16x16x32_bf16 v[68:71], a[72:75], a[112:115], v[68:71]
    buffer_load_dwordx4 a[104:107], v1, s[8:11], s25 offen offset:2048
    v_mfma_f32_16x16x32_bf16 v[72:75], a[76:79], a[112:115], v[72:75]
    ds_read_b128 a[112:115], v3 offset:704
    s_waitcnt lgkmcnt(3)
    v_mfma_f32_16x16x32_bf16 v[76:79], a[64:67], a[116:119], v[76:79]
    buffer_load_dwordx4 a[108:111], v1, s[8:11], s25 offen offset:3072
    v_mfma_f32_16x16x32_bf16 v[80:83], a[68:71], a[116:119], v[80:83]
    s_add_u32 s25, s25, 26624
    v_mfma_f32_16x16x32_bf16 v[84:87], a[72:75], a[116:119], v[84:87]
    v_xor_b32 v6, 0x400, v6
    v_mfma_f32_16x16x32_bf16 v[88:91], a[76:79], a[116:119], v[88:91]
    ds_read_b128 a[116:119], v3 offset:14528
    s_waitcnt lgkmcnt(3)
    v_mfma_f32_16x16x32_bf16 v[92:95], a[16:19], a[120:123], v[92:95]
    s_xor_b32 s52, s52, 0x400
    v_mfma_f32_16x16x32_bf16 v[96:99], a[20:23], a[120:123], v[96:99]
    s_add_u32 m0, s52, 57344
    v_mfma_f32_16x16x32_bf16 v[100:103], a[24:27], a[120:123], v[100:103]
    s_add_u32 s43, s43, 832
    v_mfma_f32_16x16x32_bf16 v[104:107], a[28:31], a[120:123], v[104:107]
    ds_read_b128 a[120:123], v3 offset:28160
    s_waitcnt lgkmcnt(3)
    v_mfma_f32_16x16x32_bf16 v[108:111], a[16:19], a[124:127], v[108:111]
    v_mfma_f32_16x16x32_bf16 v[112:115], a[20:23], a[124:127], v[112:115]
    v_mfma_f32_16x16x32_bf16 v[116:119], a[24:27], a[124:127], v[116:119]
    v_mfma_f32_16x16x32_bf16 v[120:123], a[28:31], a[124:127], v[120:123]
    ds_read_b128 a[124:127], v3 offset:41984
    s_waitcnt vmcnt(4)
    s_waitcnt lgkmcnt(3)
    v_mfma_f32_16x16x32_bf16 v[60:63], a[80:83], a[112:115], v[60:63]
    buffer_load_dwordx4 a[0:3], v1, s[8:11], s25 offen offset:0
    v_mfma_f32_16x16x32_bf16 v[64:67], a[84:87], a[112:115], v[64:67]
    v_mfma_f32_16x16x32_bf16 v[68:71], a[88:91], a[112:115], v[68:71]
    buffer_load_dwordx4 a[4:7], v1, s[8:11], s25 offen offset:1024
    v_mfma_f32_16x16x32_bf16 v[72:75], a[92:95], a[112:115], v[72:75]
    ds_read_b128 a[112:115], v3 offset:768
    s_waitcnt lgkmcnt(3)
    v_mfma_f32_16x16x32_bf16 v[76:79], a[80:83], a[116:119], v[76:79]
    buffer_load_dwordx4 a[8:11], v1, s[8:11], s25 offen offset:2048
    v_mfma_f32_16x16x32_bf16 v[80:83], a[84:87], a[116:119], v[80:83]
    v_mfma_f32_16x16x32_bf16 v[84:87], a[88:91], a[116:119], v[84:87]
    v_mfma_f32_16x16x32_bf16 v[88:91], a[92:95], a[116:119], v[88:91]
    ds_read_b128 a[116:119], v3 offset:14592
    buffer_load_dwordx4 a[12:15], v1, s[8:11], s25 offen offset:3072
    s_waitcnt lgkmcnt(3)
    v_mfma_f32_16x16x32_bf16 v[92:95], a[32:35], a[120:123], v[92:95]
    v_mfma_f32_16x16x32_bf16 v[96:99], a[36:39], a[120:123], v[96:99]
    s_add_u32 s25, s25, 26624
    v_mfma_f32_16x16x32_bf16 v[100:103], a[40:43], a[120:123], v[100:103]
    v_mfma_f32_16x16x32_bf16 v[104:107], a[44:47], a[120:123], v[104:107]
    ds_read_b128 a[120:123], v3 offset:28224
    s_waitcnt lgkmcnt(3)
    v_mfma_f32_16x16x32_bf16 v[108:111], a[32:35], a[124:127], v[108:111]
    v_mfma_f32_16x16x32_bf16 v[112:115], a[36:39], a[124:127], v[112:115]
    v_mfma_f32_16x16x32_bf16 v[116:119], a[40:43], a[124:127], v[116:119]
    v_mfma_f32_16x16x32_bf16 v[120:123], a[44:47], a[124:127], v[120:123]
    ds_read_b128 a[124:127], v3 offset:42048
    s_waitcnt vmcnt(4)
    s_waitcnt lgkmcnt(3)
    v_mfma_f32_16x16x32_bf16 v[60:63], a[96:99], a[112:115], v[60:63]
    buffer_load_dwordx4 a[16:19], v1, s[8:11], s25 offen offset:0
    v_mfma_f32_16x16x32_bf16 v[64:67], a[100:103], a[112:115], v[64:67]
    v_mfma_f32_16x16x32_bf16 v[68:71], a[104:107], a[112:115], v[68:71]
    buffer_load_dwordx4 a[20:23], v1, s[8:11], s25 offen offset:1024
    v_mfma_f32_16x16x32_bf16 v[72:75], a[108:111], a[112:115], v[72:75]
    s_waitcnt lgkmcnt(2)
    v_mfma_f32_16x16x32_bf16 v[76:79], a[96:99], a[116:119], v[76:79]
    buffer_load_dwordx4 a[24:27], v1, s[8:11], s25 offen offset:2048
    v_mfma_f32_16x16x32_bf16 v[80:83], a[100:103], a[116:119], v[80:83]
    v_mfma_f32_16x16x32_bf16 v[84:87], a[104:107], a[116:119], v[84:87]
    v_mfma_f32_16x16x32_bf16 v[88:91], a[108:111], a[116:119], v[88:91]
    buffer_load_dwordx4 a[28:31], v1, s[8:11], s25 offen offset:3072
    s_waitcnt lgkmcnt(1)
    v_mfma_f32_16x16x32_bf16 v[92:95], a[48:51], a[120:123], v[92:95]
    v_lshlrev_b32 v12, 16, v28
    v_and_b32 v13, 0xffff0000, v28
    v_lshlrev_b32 v14, 16, v29
    v_mfma_f32_16x16x32_bf16 v[96:99], a[52:55], a[120:123], v[96:99]
    s_add_u32 s25, s25, 26624
    v_and_b32 v15, 0xffff0000, v29
    v_lshlrev_b32 v16, 16, v30
    v_and_b32 v17, 0xffff0000, v30
    v_mfma_f32_16x16x32_bf16 v[100:103], a[56:59], a[120:123], v[100:103]
    v_lshlrev_b32 v18, 16, v31
    v_and_b32 v19, 0xffff0000, v31
    v_mul_f32 v12, v60, v12
    v_mfma_f32_16x16x32_bf16 v[104:107], a[60:63], a[120:123], v[104:107]
    ds_read_b128 a[120:123], v3 offset:28288
    v_mul_f32 v13, v61, v13
    v_mul_f32 v14, v62, v14
    v_mul_f32 v15, v63, v15
    s_waitcnt lgkmcnt(1)
    v_mfma_f32_16x16x32_bf16 v[108:111], a[48:51], a[124:127], v[108:111]
    v_mul_f32 v16, v64, v16
    v_mul_f32 v17, v65, v17
    v_mul_f32 v18, v66, v18
    v_mfma_f32_16x16x32_bf16 v[112:115], a[52:55], a[124:127], v[112:115]
    v_mul_f32 v19, v67, v19
    v_cvt_pk_bf16_f32 v8, v12, v13
    v_cvt_pk_bf16_f32 v9, v14, v15
    v_mfma_f32_16x16x32_bf16 v[116:119], a[56:59], a[124:127], v[116:119]
    v_cvt_pk_bf16_f32 v10, v16, v17
    v_cvt_pk_bf16_f32 v11, v18, v19
    s_nop 1
    v_permlane16_swap_b32 v8, v10
    v_mfma_f32_16x16x32_bf16 v[120:123], a[60:63], a[124:127], v[120:123]
    ds_read_b128 a[124:127], v3 offset:42112
    v_permlane16_swap_b32 v9, v11
    ds_write_b128 v4, v[8:11] offset:0
    s_waitcnt lgkmcnt(2)
    v_mfma_f32_16x16x32_bf16 v[92:95], a[64:67], a[120:123], v[92:95]
    buffer_load_dwordx4 a[32:35], v1, s[8:11], s25 offen offset:0
    v_mfma_f32_16x16x32_bf16 v[96:99], a[68:71], a[120:123], v[96:99]
    buffer_load_dwordx4 a[36:39], v1, s[8:11], s25 offen offset:1024
    v_lshlrev_b32 v12, 16, v32
    v_and_b32 v13, 0xffff0000, v32
    v_lshlrev_b32 v14, 16, v33
    v_and_b32 v15, 0xffff0000, v33
    v_mfma_f32_16x16x32_bf16 v[100:103], a[72:75], a[120:123], v[100:103]
    buffer_load_dwordx4 a[40:43], v1, s[8:11], s25 offen offset:2048
    v_lshlrev_b32 v16, 16, v34
    v_and_b32 v17, 0xffff0000, v34
    v_lshlrev_b32 v18, 16, v35
    v_and_b32 v19, 0xffff0000, v35
    v_mfma_f32_16x16x32_bf16 v[104:107], a[76:79], a[120:123], v[104:107]
    ds_read_b128 a[120:123], v3 offset:28352
    buffer_load_dwordx4 a[44:47], v1, s[8:11], s25 offen offset:3072
    v_mul_f32 v12, v68, v12
    v_mul_f32 v13, v69, v13
    v_mul_f32 v14, v70, v14
    s_waitcnt lgkmcnt(2)
    v_mfma_f32_16x16x32_bf16 v[108:111], a[64:67], a[124:127], v[108:111]
    s_add_u32 s25, s25, 26624
    v_mul_f32 v15, v71, v15
    v_mul_f32 v16, v72, v16
    v_mul_f32 v17, v73, v17
    v_mfma_f32_16x16x32_bf16 v[112:115], a[68:71], a[124:127], v[112:115]
    v_mul_f32 v18, v74, v18
    v_mul_f32 v19, v75, v19
    v_cvt_pk_bf16_f32 v8, v12, v13
    v_mfma_f32_16x16x32_bf16 v[116:119], a[72:75], a[124:127], v[116:119]
    v_cvt_pk_bf16_f32 v9, v14, v15
    v_cvt_pk_bf16_f32 v10, v16, v17
    v_cvt_pk_bf16_f32 v11, v18, v19
    v_mfma_f32_16x16x32_bf16 v[120:123], a[76:79], a[124:127], v[120:123]
    ds_read_b128 a[124:127], v3 offset:42176
    s_nop 1
    v_permlane16_swap_b32 v8, v10
    v_permlane16_swap_b32 v9, v11
    ds_write_b128 v4, v[8:11] offset:64
    s_waitcnt lgkmcnt(2)
    v_mfma_f32_16x16x32_bf16 v[92:95], a[80:83], a[120:123], v[92:95]
    v_mfma_f32_16x16x32_bf16 v[96:99], a[84:87], a[120:123], v[96:99]
    v_lshlrev_b32 v12, 16, v36
    v_and_b32 v13, 0xffff0000, v36
    v_lshlrev_b32 v14, 16, v37
    v_and_b32 v15, 0xffff0000, v37
    v_lshlrev_b32 v16, 16, v38
    v_and_b32 v17, 0xffff0000, v38
    v_lshlrev_b32 v18, 16, v39
    v_mfma_f32_16x16x32_bf16 v[100:103], a[88:91], a[120:123], v[100:103]
    v_and_b32 v19, 0xffff0000, v39
    v_mul_f32 v12, v76, v12
    v_mul_f32 v13, v77, v13
    v_mul_f32 v14, v78, v14
    v_mul_f32 v15, v79, v15
    v_mul_f32 v16, v80, v16
    v_mul_f32 v17, v81, v17
    v_mfma_f32_16x16x32_bf16 v[104:107], a[92:95], a[120:123], v[104:107]
    ds_read_b128 a[120:123], v3 offset:28416
    v_mul_f32 v18, v82, v18
    v_mul_f32 v19, v83, v19
    v_cvt_pk_bf16_f32 v8, v12, v13
    v_cvt_pk_bf16_f32 v9, v14, v15
    v_cvt_pk_bf16_f32 v10, v16, v17
    v_cvt_pk_bf16_f32 v11, v18, v19
    s_nop 1
    v_permlane16_swap_b32 v8, v10
    s_waitcnt lgkmcnt(2)
    v_mfma_f32_16x16x32_bf16 v[108:111], a[80:83], a[124:127], v[108:111]
    v_permlane16_swap_b32 v9, v11
    ds_write_b128 v4, v[8:11] offset:13824
    v_lshlrev_b32 v12, 16, v40
    v_and_b32 v13, 0xffff0000, v40
    v_lshlrev_b32 v14, 16, v41
    v_and_b32 v15, 0xffff0000, v41
    v_lshlrev_b32 v16, 16, v42
    v_mfma_f32_16x16x32_bf16 v[112:115], a[84:87], a[124:127], v[112:115]
    v_and_b32 v17, 0xffff0000, v42
    v_lshlrev_b32 v18, 16, v43
    v_and_b32 v19, 0xffff0000, v43
    v_mul_f32 v12, v84, v12
    v_mul_f32 v13, v85, v13
    v_mul_f32 v14, v86, v14
    v_mfma_f32_16x16x32_bf16 v[116:119], a[88:91], a[124:127], v[116:119]
    v_mul_f32 v15, v87, v15
    v_mul_f32 v16, v88, v16
    v_mul_f32 v17, v89, v17
    v_mul_f32 v18, v90, v18
    v_mul_f32 v19, v91, v19
    v_cvt_pk_bf16_f32 v8, v12, v13
    v_mfma_f32_16x16x32_bf16 v[120:123], a[92:95], a[124:127], v[120:123]
    ds_read_b128 a[124:127], v3 offset:42240
    v_cvt_pk_bf16_f32 v9, v14, v15
    v_cvt_pk_bf16_f32 v10, v16, v17
    v_cvt_pk_bf16_f32 v11, v18, v19
    s_nop 1
    v_permlane16_swap_b32 v8, v10
    v_permlane16_swap_b32 v9, v11
    ds_write_b128 v4, v[8:11] offset:13888
    s_waitcnt lgkmcnt(0)
    s_barrier
    v_xor_b32 v3, 65536, v3
    v_mfma_f32_16x16x32_bf16 v[92:95], a[96:99], a[120:123], v[92:95]
    ds_read_b128 a[112:115], v3 offset:0
    ds_read_b128 a[116:119], v3 offset:13824
    v_mfma_f32_16x16x32_bf16 v[96:99], a[100:103], a[120:123], v[96:99]
    buffer_load_dwordx4 a[48:51], v1, s[8:11], s25 offen offset:0
    v_mfma_f32_16x16x32_bf16 v[100:103], a[104:107], a[120:123], v[100:103]
    buffer_load_dwordx4 a[52:55], v1, s[8:11], s25 offen offset:1024
    v_mfma_f32_16x16x32_bf16 v[104:107], a[108:111], a[120:123], v[104:107]
    buffer_load_dwordx4 a[56:59], v1, s[8:11], s25 offen offset:2048
    v_mfma_f32_16x16x32_bf16 v[108:111], a[96:99], a[124:127], v[108:111]
    buffer_load_dwordx4 a[60:63], v1, s[8:11], s25 offen offset:3072
    v_mfma_f32_16x16x32_bf16 v[112:115], a[100:103], a[124:127], v[112:115]
    s_add_u32 s25, s25, 26624
    v_lshlrev_b32 v12, 16, v44
    v_and_b32 v13, 0xffff0000, v44
    v_lshlrev_b32 v14, 16, v45
    v_and_b32 v15, 0xffff0000, v45
    v_lshlrev_b32 v16, 16, v46
    v_and_b32 v17, 0xffff0000, v46
    v_lshlrev_b32 v18, 16, v47
    v_and_b32 v19, 0xffff0000, v47
    v_mfma_f32_16x16x32_bf16 v[116:119], a[104:107], a[124:127], v[116:119]
    v_mul_f32 v12, v92, v12
    v_mul_f32 v13, v93, v13
    v_mul_f32 v14, v94, v14
    v_mul_f32 v15, v95, v15
    v_mul_f32 v16, v96, v16
    v_mul_f32 v17, v97, v17
    v_mul_f32 v18, v98, v18
    v_mul_f32 v19, v99, v19
    v_mfma_f32_16x16x32_bf16 v[120:123], a[108:111], a[124:127], v[120:123]
    v_cvt_pk_bf16_f32 v8, v12, v13
    v_cvt_pk_bf16_f32 v9, v14, v15
    v_cvt_pk_bf16_f32 v10, v16, v17
    v_cvt_pk_bf16_f32 v11, v18, v19
    s_nop 1
    v_permlane16_swap_b32 v8, v10
    v_permlane16_swap_b32 v9, v11
    ds_write_b128 v4, v[8:11] offset:27648
    s_add_u32 s28, s28, 1
    s_cmp_lt_u32 s28, 6
    s_waitcnt lgkmcnt(0)
    s_cbranch_scc1 L_layer4
    s_nop 7
    v_lshlrev_b32 v12, 16, v48
    v_and_b32 v13, 0xffff0000, v48
    v_lshlrev_b32 v14, 16, v49
    v_and_b32 v15, 0xffff0000, v49
    v_lshlrev_b32 v16, 16, v50
    v_and_b32 v17, 0xffff0000, v50
    v_lshlrev_b32 v18, 16, v51
    v_and_b32 v19, 0xffff0000, v51
    v_mul_f32 v12, v100, v12
    v_mul_f32 v13, v101, v13
    v_mul_f32 v14, v102, v14
    v_mul_f32 v15, v103, v15
    v_mul_f32 v16, v104, v16
    v_mul_f32 v17, v105, v17
    v_mul_f32 v18, v106, v18
    v_mul_f32 v19, v107, v19
    v_cvt_pk_bf16_f32 v8, v12, v13
    v_cvt_pk_bf16_f32 v9, v14, v15
    v_cvt_pk_bf16_f32 v10, v16, v17
    v_cvt_pk_bf16_f32 v11, v18, v19
    s_nop 1
    v_permlane16_swap_b32 v8, v10
    v_permlane16_swap_b32 v9, v11
    ds_write_b128 v4, v[8:11] offset:27712
    v_lshlrev_b32 v12, 16, v52
    v_and_b32 v13, 0xffff0000, v52
    v_lshlrev_b32 v14, 16, v53
    v_and_b32 v15, 0xffff0000, v53
    v_lshlrev_b32 v16, 16, v54
    v_and_b32 v17, 0xffff0000, v54
    v_lshlrev_b32 v18, 16, v55
    v_and_b32 v19, 0xffff0000, v55
    v_mul_f32 v12, v108, v12
    v_mul_f32 v13, v109, v13
    v_mul_f32 v14, v110, v14
    v_mul_f32 v15, v111, v15
    v_mul_f32 v16, v112, v16
    v_mul_f32 v17, v113, v17
    v_mul_f32 v18, v114, v18
    v_mul_f32 v19, v115, v19
    v_cvt_pk_bf16_f32 v8, v12, v13
    v_cvt_pk_bf16_f32 v9, v14, v15
    v_cvt_pk_bf16_f32 v10, v16, v17
    v_cvt_pk_bf16_f32 v11, v18, v19
    s_nop 1
    v_permlane16_swap_b32 v8, v10
    v_permlane16_swap_b32 v9, v11
    ds_write_b128 v4, v[8:11] offset:41472
    v_lshlrev_b32 v12, 16, v56
    v_and_b32 v13, 0xffff0000, v56
    v_lshlrev_b32 v14, 16, v57
    v_and_b32 v15, 0xffff0000, v57
    v_lshlrev_b32 v16, 16, v58
    v_and_b32 v17, 0xffff0000, v58
    v_lshlrev_b32 v18, 16, v59
    v_and_b32 v19, 0xffff0000, v59
    v_mul_f32 v12, v116, v12
    v_mul_f32 v13, v117, v13
    v_mul_f32 v14, v118, v14
    v_mul_f32 v15, v119, v15
    v_mul_f32 v16, v120, v16
    v_mul_f32 v17, v121, v17
    v_mul_f32 v18, v122, v18
    v_mul_f32 v19, v123, v19
    v_cvt_pk_bf16_f32 v8, v12, v13
    v_cvt_pk_bf16_f32 v9, v14, v15
    v_cvt_pk_bf16_f32 v10, v16, v17
    v_cvt_pk_bf16_f32 v11, v18, v19
    s_nop 1
    v_permlane16_swap_b32 v8, v10
    v_permlane16_swap_b32 v9, v11
    ds_write_b128 v4, v[8:11] offset:41536
    s_branch L_fin
L_start3:
    buffer_load_dwordx4 a[0:3], v1, s[8:11], s25 offen offset:0
    buffer_load_dwordx4 a[4:7], v1, s[8:11], s25 offen offset:1024
    buffer_load_dwordx4 a[8:11], v1, s[8:11], s25 offen offset:2048
    s_add_u32 s25, s25, 26624
    s_mov_b32 m0, s39
    s_mov_b64 exec, s[36:37]
    buffer_load_dwordx4 v26, s[12:15], s38 offen nt lds
    s_mov_b64 exec, -1
    s_add_u32 s39, s39, 864
    s_add_u32 s38, s38, 832
    s_mov_b32 m0, s39
    s_mov_b64 exec, s[36:37]
    buffer_load_dwordx4 v26, s[12:15], s38 offen nt lds
    s_mov_b64 exec, -1
    s_add_u32 s39, s39, 864
    s_add_u32 s38, s38, 832
    s_mov_b32 m0, s39
    s_mov_b64 exec, s[36:37]
    buffer_load_dwordx4 v26, s[12:15], s38 offen nt lds
    s_mov_b64 exec, -1
    s_add_u32 s39, s39, 864
    s_add_u32 s38, s38, 832
    s_mov_b32 m0, s39
    s_mov_b64 exec, s[36:37]
    buffer_load_dwordx4 v26, s[12:15], s38 offen nt lds
    s_mov_b64 exec, -1
    s_add_u32 s39, s39, 864
    s_add_u32 s38, s38, 832
    buffer_load_dwordx4 a[16:19], v1, s[8:11], s25 offen offset:0
    buffer_load_dwordx4 a[20:23], v1, s[8:11], s25 offen offset:1024
    buffer_load_dwordx4 a[24:27], v1, s[8:11], s25 offen offset:2048
    s_add_u32 s25, s25, 26624
    v_mov_b32 v60, 1.0
    v_mov_b32 v61, 1.0
    v_mov_b32 v62, 1.0
    v_mov_b32 v63, 1.0
    v_mov_b32 v64, 1.0
    v_mov_b32 v65, 1.0
    v_mov_b32 v66, 1.0
    v_mov_b32 v67, 1.0
    v_mov_b32 v68, 1.0
    v_mov_b32 v69, 1.0
    v_mov_b32 v70, 1.0
    v_mov_b32 v71, 1.0
    v_mov_b32 v76, 1.0
    v_mov_b32 v77, 1.0
    v_mov_b32 v78, 1.0
    v_mov_b32 v79, 1.0
    v_mov_b32 v80, 1.0
    v_mov_b32 v81, 1.0
    v_mov_b32 v82, 1.0
    v_mov_b32 v83, 1.0
    v_mov_b32 v84, 1.0
    v_mov_b32 v85, 1.0
    v_mov_b32 v86, 1.0
    v_mov_b32 v87, 1.0
    v_mov_b32 v92, 1.0
    v_mov_b32 v93, 1.0
    v_mov_b32 v94, 1.0
    v_mov_b32 v95, 1.0
    v_mov_b32 v96, 1.0
    v_mov_b32 v97, 1.0
    v_mov_b32 v98, 1.0
    v_mov_b32 v99, 1.0
    v_mov_b32 v100, 1.0
    v_mov_b32 v101, 1.0
    v_mov_b32 v102, 1.0
    v_mov_b32 v103, 1.0
    v_mov_b32 v108, 1.0
    v_mov_b32 v109, 1.0
    v_mov_b32 v110, 1.0
    v_mov_b32 v111, 1.0
    v_mov_b32 v112, 1.0
    v_mov_b32 v113, 1.0
    v_mov_b32 v114, 1.0
    v_mov_b32 v115, 1.0
    v_mov_b32 v116, 1.0
    v_mov_b32 v117, 1.0
    v_mov_b32 v118, 1.0
    v_mov_b32 v119, 1.0
    s_waitcnt vmcnt(10)
    s_barrier
    ds_read_b128 a[112:115], v3 offset:0
    ds_read_b128 a[116:119], v3 offset:13824
    s_waitcnt vmcnt(7)
    s_waitcnt lgkmcnt(1)
    v_mfma_f32_16x16x32_bf16 v[60:63], a[0:3], a[112:115], v[60:63]
    s_cmp_eq_u32 s24, 7
    s_cbranch_scc0 L_nb0
    s_mov_b32 m0, 57344
    s_mov_b64 exec, s[36:37]
    buffer_load_dwordx4 v25, s[20:23], 0 offen lds
    s_mov_b64 exec, -1
L_nb0:
    buffer_load_dwordx4 a[32:35], v1, s[8:11], s25 offen offset:0
    buffer_load_dwordx4 a[36:39], v1, s[8:11], s25 offen offset:1024
    v_mfma_f32_16x16x32_bf16 v[64:67], a[4:7], a[112:115], v[64:67]
    buffer_load_dwordx4 a[40:43], v1, s[8:11], s25 offen offset:2048
    s_add_u32 s25, s25, 26624
    v_mfma_f32_16x16x32_bf16 v[68:71], a[8:11], a[112:115], v[68:71]
    ds_read_b128 a[112:115], v3 offset:64
    buffer_load_dwordx4 a[48:51], v1, s[8:11], s25 offen offset:0
    buffer_load_dwordx4 a[52:55], v1, s[8:11], s25 offen offset:1024
    s_waitcnt lgkmcnt(1)
    v_mfma_f32_16x16x32_bf16 v[76:79], a[0:3], a[116:119], v[76:79]
    buffer_load_dwordx4 a[56:59], v1, s[8:11], s25 offen offset:2048
    s_add_u32 s25, s25, 26624
    v_mfma_f32_16x16x32_bf16 v[80:83], a[4:7], a[116:119], v[80:83]
    v_mfma_f32_16x16x32_bf16 v[84:87], a[8:11], a[116:119], v[84:87]
    ds_read_b128 a[116:119], v3 offset:13888
    s_waitcnt vmcnt(6)
    s_waitcnt lgkmcnt(1)
    v_mfma_f32_16x16x32_bf16 v[60:63], a[16:19], a[112:115], v[60:63]
    buffer_load_dwordx4 a[64:67], v1, s[8:11], s25 offen offset:0
    v_mfma_f32_16x16x32_bf16 v[64:67], a[20:23], a[112:115], v[64:67]
    buffer_load_dwordx4 a[68:71], v1, s[8:11], s25 offen offset:1024
    v_mfma_f32_16x16x32_bf16 v[68:71], a[24:27], a[112:115], v[68:71]
    ds_read_b128 a[112:115], v3 offset:128
    buffer_load_dwordx4 a[72:75], v1, s[8:11], s25 offen offset:2048
    s_waitcnt lgkmcnt(1)
    v_mfma_f32_16x16x32_bf16 v[76:79], a[16:19], a[116:119], v[76:79]
    s_add_u32 s25, s25, 26624
    v_mfma_f32_16x16x32_bf16 v[80:83], a[20:23], a[116:119], v[80:83]
    v_mfma_f32_16x16x32_bf16 v[84:87], a[24:27], a[116:119], v[84:87]
    ds_read_b128 a[116:119], v3 offset:13952
    s_waitcnt vmcnt(6) lgkmcnt(0)
    s_barrier
    v_mfma_f32_16x16x32_bf16 v[60:63], a[32:35], a[112:115], v[60:63]
    ds_read_b128 a[120:123], v3 offset:27648
    v_mfma_f32_16x16x32_bf16 v[64:67], a[36:39], a[112:115], v[64:67]
    v_mfma_f32_16x16x32_bf16 v[68:71], a[40:43], a[112:115], v[68:71]
    ds_read_b128 a[112:115], v3 offset:192
    ds_read_b128 a[124:127], v3 offset:41472
    v_mfma_f32_16x16x32_bf16 v[76:79], a[32:35], a[116:119], v[76:79]
    v_mfma_f32_16x16x32_bf16 v[80:83], a[36:39], a[116:119], v[80:83]
    v_mfma_f32_16x16x32_bf16 v[84:87], a[40:43], a[116:119], v[84:87]
    ds_read_b128 a[116:119], v3 offset:14016
    s_branch L_sS_3
.p2align 6
L_layer3:
    s_waitcnt vmcnt(9)
    v_mfma_f32_16x16x32_bf16 v[60:63], a[0:3], a[112:115], v[60:63]
    v_mfma_f32_16x16x32_bf16 v[64:67], a[4:7], a[112:115], v[64:67]
    v_mfma_f32_16x16x32_bf16 v[68:71], a[8:11], a[112:115], v[68:71]
    ds_read_b128 a[112:115], v3 offset:64
    v_lshlrev_b32 v12, 16, v52
    v_and_b32 v13, 0xffff0000, v52
    v_lshlrev_b32 v14, 16, v53
    v_and_b32 v15, 0xffff0000, v53
    v_lshlrev_b32 v16, 16, v54
    v_and_b32 v17, 0xffff0000, v54
    v_mfma_f32_16x16x32_bf16 v[76:79], a[0:3], a[116:119], v[76:79]
    v_lshlrev_b32 v18, 16, v55
    v_and_b32 v19, 0xffff0000, v55
    v_mul_f32 v12, v108, v12
    v_mul_f32 v13, v109, v13
    v_mul_f32 v14, v110, v14
    v_mul_f32 v15, v111, v15
    v_mfma_f32_16x16x32_bf16 v[80:83], a[4:7], a[116:119], v[80:83]
    v_mul_f32 v16, v112, v16
    v_mul_f32 v17, v113, v17
    v_mul_f32 v18, v114, v18
    v_mul_f32 v19, v115, v19
    v_cvt_pk_bf16_f32 v8, v12, v13
    v_cvt_pk_bf16_f32 v9, v14, v15
    v_mfma_f32_16x16x32_bf16 v[84:87], a[8:11], a[116:119], v[84:87]
    ds_read_b128 a[116:119], v3 offset:13888
    v_cvt_pk_bf16_f32 v10, v16, v17
    v_cvt_pk_bf16_f32 v11, v18, v19
    s_nop 1
    v_permlane16_swap_b32 v8, v10
    v_permlane16_swap_b32 v9, v11
    ds_write_b128 v4, v[8:11] offset:41472
    s_waitcnt vmcnt(6)
    s_waitcnt lgkmcnt(2)
    v_mfma_f32_16x16x32_bf16 v[60:63], a[16:19], a[112:115], v[60:63]
    buffer_load_dwordx4 a[64:67], v1, s[8:11], s25 offen offset:0
    v_mfma_f32_16x16x32_bf16 v[64:67], a[20:23], a[112:115], v[64:67]
    buffer_load_dwordx4 a[68:71], v1, s[8:11], s25 offen offset:1024
    v_mfma_f32_16x16x32_bf16 v[68:71], a[24:27], a[112:115], v[68:71]
    ds_read_b128 a[112:115], v3 offset:128
    buffer_load_dwordx4 a[72:75], v1, s[8:11], s25 offen offset:2048
    v_lshlrev_b32 v12, 16, v48
    v_and_b32 v13, 0xffff0000, v48
    v_lshlrev_b32 v14, 16, v49
    v_and_b32 v15, 0xffff0000, v49
    v_lshlrev_b32 v16, 16, v56
    v_and_b32 v17, 0xffff0000, v56
    s_waitcnt lgkmcnt(2)
    v_mfma_f32_16x16x32_bf16 v[76:79], a[16:19], a[116:119], v[76:79]
    s_add_u32 s25, s25, 26624
    v_lshlrev_b32 v18, 16, v57
    v_and_b32 v19, 0xffff0000, v57
    v_mul_f32 v12, v100, v12
    v_mul_f32 v13, v101, v13
    v_mul_f32 v14, v102, v14
    v_mul_f32 v15, v103, v15
    v_mfma_f32_16x16x32_bf16 v[80:83], a[20:23], a[116:119], v[80:83]
    v_mul_f32 v16, v116, v16
    v_mul_f32 v17, v117, v17
    v_mul_f32 v18, v118, v18
    v_mul_f32 v19, v119, v19
    v_cvt_pk_bf16_f32 v8, v12, v13
    v_cvt_pk_bf16_f32 v9, v14, v15
    v_mfma_f32_16x16x32_bf16 v[84:87], a[24:27], a[116:119], v[84:87]
    ds_read_b128 a[116:119], v3 offset:13952
    v_cvt_pk_bf16_f32 v10, v16, v17
    v_cvt_pk_bf16_f32 v11, v18, v19
    s_nop 1
    v_permlane16_swap_b32 v8, v10
    v_permlane16_swap_b32 v9, v11
    ds_write_b128 v5, v[8:11] offset:27648
    s_waitcnt vmcnt(6) lgkmcnt(0)
    s_barrier
    v_mfma_f32_16x16x32_bf16 v[60:63], a[32:35], a[112:115], v[60:63]
    ds_read_b128 a[120:123], v3 offset:27648
    v_mfma_f32_16x16x32_bf16 v[64:67], a[36:39], a[112:115], v[64:67]
    v_mfma_f32_16x16x32_bf16 v[68:71], a[40:43], a[112:115], v[68:71]
    ds_read_b128 a[112:115], v3 offset:192
    ds_read_b128 a[124:127], v3 offset:41472
    v_mfma_f32_16x16x32_bf16 v[76:79], a[32:35], a[116:119], v[76:79]
    v_mfma_f32_16x16x32_bf16 v[80:83], a[36:39], a[116:119], v[80:83]
    v_mfma_f32_16x16x32_bf16 v[84:87], a[40:43], a[116:119], v[84:87]
    ds_read_b128 a[116:119], v3 offset:14016
L_sS_3:
    s_waitcnt vmcnt(3)
    v_mfma_f32_16x16x32_bf16 v[60:63], a[48:51], a[112:115], v[60:63]
    buffer_load_dwordx4 a[80:83], v1, s[8:11], s25 offen offset:0
    v_mfma_f32_16x16x32_bf16 v[64:67], a[52:55], a[112:115], v[64:67]
    buffer_load_dwordx4 a[84:87], v1, s[8:11], s25 offen offset:1024
    v_mfma_f32_16x16x32_bf16 v[68:71], a[56:59], a[112:115], v[68:71]
    ds_read_b128 a[112:115], v3 offset:256
    buffer_load_dwordx4 a[88:91], v1, s[8:11], s25 offen offset:2048
    v_mfma_f32_16x16x32_bf16 v[76:79], a[48:51], a[116:119], v[76:79]
    s_add_u32 s25, s25, 26624
    v_mfma_f32_16x16x32_bf16 v[80:83], a[52:55], a[116:119], v[80:83]
    ds_read_b64 v[20:21], v6 offset:0
    v_mfma_f32_16x16x32_bf16 v[84:87], a[56:59], a[116:119], v[84:87]
    ds_read_b128 a[116:119], v3 offset:14080
    ds_read_b64 v[22:23], v6 offset:32
    v_mfma_f32_16x16x32_bf16 v[92:95], a[0:3], a[120:123], v[92:95]
    s_cmp_eq_u32 s28, 0
    s_cbranch_scc0 L_cv27
    ds_read_b64 v[28:29], v7 offset:0
    ds_read_b64 v[30:31], v7 offset:32
    ds_read_b64 v[32:33], v7 offset:64
    ds_read_b64 v[36:37], v7 offset:13824
L_cv27:
    ds_read_b64 v[24:25], v6 offset:64
    v_mfma_f32_16x16x32_bf16 v[96:99], a[4:7], a[120:123], v[96:99]
    s_cmp_ge_u32 s24, 6
    s_cbranch_scc0 L_pf26
    v_lshlrev_b32 v8, 7, v0
    buffer_load_dword v2, v8, s[8:11], s57 offen
    s_add_u32 s57, s57, 346112
L_pf26:
    v_mfma_f32_16x16x32_bf16 v[100:103], a[8:11], a[120:123], v[100:103]
    ds_read_b128 a[120:123], v3 offset:27712
    v_mfma_f32_16x16x32_bf16 v[108:111], a[0:3], a[124:127], v[108:111]
    v_mfma_f32_16x16x32_bf16 v[112:115], a[4:7], a[124:127], v[112:115]
    v_mfma_f32_16x16x32_bf16 v[116:119], a[8:11], a[124:127], v[116:119]
    ds_read_b128 a[124:127], v3 offset:41536
    s_waitcnt vmcnt(3)
    s_waitcnt lgkmcnt(6)
    v_mfma_f32_16x16x32_bf16 v[60:63], a[64:67], a[112:115], v[60:63]
    s_waitcnt lgkmcnt(5)
    v_lshlrev_b32 v8, 16, v20
    v_and_b32 v9, 0xffff0000, v20
    v_lshlrev_b32 v10, 16, v21
    v_and_b32 v11, 0xffff0000, v21
    v_add_f32 v94, v10, v94
    v_add_f32 v95, v11, v95
    v_xor_b32 v4, 65536, v4
    v_mfma_f32_16x16x32_bf16 v[64:67], a[68:71], a[112:115], v[64:67]
    v_xor_b32 v5, 65536, v5
    v_mfma_f32_16x16x32_bf16 v[68:71], a[72:75], a[112:115], v[68:71]
    ds_read_b128 a[112:115], v3 offset:320
    v_add_f32 v108, v8, v108
    v_add_f32 v109, v9, v109
    s_waitcnt lgkmcnt(5)
    v_mfma_f32_16x16x32_bf16 v[76:79], a[64:67], a[116:119], v[76:79]
    v_add_f32 v110, v10, v110
    v_add_f32 v111, v11, v111
    buffer_load_dwordx4 a[0:3], v1, s[8:11], s25 offen offset:0
    v_mfma_f32_16x16x32_bf16 v[80:83], a[68:71], a[116:119], v[80:83]
    buffer_load_dwordx4 a[4:7], v1, s[8:11], s25 offen offset:1024
    v_mfma_f32_16x16x32_bf16 v[84:87], a[72:75], a[116:119], v[84:87]
    ds_read_b128 a[116:119], v3 offset:14144
    v_add_f32 v60, v8, v60
    v_add_f32 v61, v9, v61
    s_waitcnt lgkmcnt(3)
    v_mfma_f32_16x16x32_bf16 v[92:95], a[16:19], a[120:123], v[92:95]
    s_cmp_eq_u32 s28, 0
    s_cbranch_scc0 L_cv28
    ds_read_b64 v[38:39], v7 offset:13856
    ds_read_b64 v[40:41], v7 offset:13888
    ds_read_b64 v[44:45], v7 offset:27648
    ds_read_b64 v[46:47], v7 offset:27680
L_cv28:
    v_add_f32 v62, v10, v62
    v_add_f32 v63, v11, v63
    buffer_load_dwordx4 a[8:11], v1, s[8:11], s25 offen offset:2048
    v_mfma_f32_16x16x32_bf16 v[96:99], a[20:23], a[120:123], v[96:99]
    s_add_u32 s25, s25, 26624
    v_mfma_f32_16x16x32_bf16 v[100:103], a[24:27], a[120:123], v[100:103]
    ds_read_b128 a[120:123], v3 offset:27776
    v_add_f32 v76, v8, v76
    v_add_f32 v77, v9, v77
    s_waitcnt lgkmcnt(3)
    v_mfma_f32_16x16x32_bf16 v[108:111], a[16:19], a[124:127], v[108:111]
    v_add_f32 v78, v10, v78
    v_add_f32 v79, v11, v79
    v_mfma_f32_16x16x32_bf16 v[112:115], a[20:23], a[124:127], v[112:115]
    v_mfma_f32_16x16x32_bf16 v[116:119], a[24:27], a[124:127], v[116:119]
    ds_read_b128 a[124:127], v3 offset:41600
    v_add_f32 v92, v8, v92
    v_add_f32 v93, v9, v93
    s_waitcnt vmcnt(3)
    s_waitcnt lgkmcnt(3)
    v_mfma_f32_16x16x32_bf16 v[60:63], a[80:83], a[112:115], v[60:63]
    v_lshlrev_b32 v8, 16, v22
    v_and_b32 v9, 0xffff0000, v22
    v_lshlrev_b32 v10, 16, v23
    v_and_b32 v11, 0xffff0000, v23
    v_add_f32 v96, v8, v96
    v_add_f32 v97, v9, v97
    buffer_load_dwordx4 a[16:19], v1, s[8:11], s25 offen offset:0
    v_mfma_f32_16x16x32_bf16 v[64:67], a[84:87], a[112:115], v[64:67]
    v_add_f32 v98, v10, v98
    v_add_f32 v99, v11, v99
    v_mfma_f32_16x16x32_bf16 v[68:71], a[88:91], a[112:115], v[68:71]
    ds_read_b128 a[112:115], v3 offset:384
    buffer_load_dwordx4 a[20:23], v1, s[8:11], s25 offen offset:1024
    s_waitcnt lgkmcnt(3)
    v_mfma_f32_16x16x32_bf16 v[76:79], a[80:83], a[116:119], v[76:79]
    v_add_f32 v112, v8, v112
    v_add_f32 v113, v9, v113
    v_mfma_f32_16x16x32_bf16 v[80:83], a[84:87], a[116:119], v[80:83]
    v_add_f32 v114, v10, v114
    v_add_f32 v115, v11, v115
    buffer_load_dwordx4 a[24:27], v1, s[8:11], s25 offen offset:2048
    v_mfma_f32_16x16x32_bf16 v[84:87], a[88:91], a[116:119], v[84:87]
    ds_read_b128 a[116:119], v3 offset:14208
    s_waitcnt lgkmcnt(3)
    v_mfma_f32_16x16x32_bf16 v[92:95], a[32:35], a[120:123], v[92:95]
    s_cmp_eq_u32 s28, 0
    s_cbranch_scc0 L_cv29
    ds_read_b64 v[48:49], v7 offset:27712
    ds_read_b64 v[52:53], v7 offset:41472
    ds_read_b64 v[54:55], v7 offset:41504
    ds_read_b64 v[56:57], v7 offset:41536
L_cv29:
    v_add_f32 v64, v8, v64
    v_add_f32 v65, v9, v65
    s_add_u32 s25, s25, 26624
    v_mfma_f32_16x16x32_bf16 v[96:99], a[36:39], a[120:123], v[96:99]
    v_add_f32 v66, v10, v66
    v_add_f32 v67, v11, v67
    v_mfma_f32_16x16x32_bf16 v[100:103], a[40:43], a[120:123], v[100:103]
    ds_read_b128 a[120:123], v3 offset:27840
    s_waitcnt lgkmcnt(3)
    v_mfma_f32_16x16x32_bf16 v[108:111], a[32:35], a[124:127], v[108:111]
    v_add_f32 v80, v8, v80
    v_add_f32 v81, v9, v81
    v_mfma_f32_16x16x32_bf16 v[112:115], a[36:39], a[124:127], v[112:115]
    v_add_f32 v82, v10, v82
    v_add_f32 v83, v11, v83
    v_mfma_f32_16x16x32_bf16 v[116:119], a[40:43], a[124:127], v[116:119]
    ds_read_b128 a[124:127], v3 offset:41664
    s_waitcnt vmcnt(3)
    s_waitcnt lgkmcnt(3)
    v_mfma_f32_16x16x32_bf16 v[60:63], a[0:3], a[112:115], v[60:63]
    v_lshlrev_b32 v8, 16, v24
    v_and_b32 v9, 0xffff0000, v24
    v_lshlrev_b32 v10, 16, v25
    v_and_b32 v11, 0xffff0000, v25
    buffer_load_dwordx4 a[32:35], v1, s[8:11], s25 offen offset:0
    v_mfma_f32_16x16x32_bf16 v[64:67], a[4:7], a[112:115], v[64:67]
    v_add_f32 v100, v8, v100
    v_add_f32 v101, v9, v101
    v_mfma_f32_16x16x32_bf16 v[68:71], a[8:11], a[112:115], v[68:71]
    ds_read_b128 a[112:115], v3 offset:448
    v_add_f32 v102, v10, v102
    v_add_f32 v103, v11, v103
    buffer_load_dwordx4 a[36:39], v1, s[8:11], s25 offen offset:1024
    s_waitcnt lgkmcnt(3)
    v_mfma_f32_16x16x32_bf16 v[76:79], a[0:3], a[116:119], v[76:79]
    v_mfma_f32_16x16x32_bf16 v[80:83], a[4:7], a[116:119], v[80:83]
    v_add_f32 v116, v8, v116
    v_add_f32 v117, v9, v117
    buffer_load_dwordx4 a[40:43], v1, s[8:11], s25 offen offset:2048
    v_mfma_f32_16x16x32_bf16 v[84:87], a[8:11], a[116:119], v[84:87]
    ds_read_b128 a[116:119], v3 offset:14272
    v_add_f32 v118, v10, v118
    v_add_f32 v119, v11, v119
    s_waitcnt lgkmcnt(3)
    v_mfma_f32_16x16x32_bf16 v[92:95], a[48:51], a[120:123], v[92:95]
    s_add_u32 s25, s25, 26624
    v_mfma_f32_16x16x32_bf16 v[96:99], a[52:55], a[120:123], v[96:99]
    v_add_f32 v68, v8, v68
    v_add_f32 v69, v9, v69
    v_mfma_f32_16x16x32_bf16 v[100:103], a[56:59], a[120:123], v[100:103]
    ds_read_b128 a[120:123], v3 offset:27904
    v_add_f32 v70, v10, v70
    v_add_f32 v71, v11, v71
    s_waitcnt lgkmcnt(3)
    v_mfma_f32_16x16x32_bf16 v[108:111], a[48:51], a[124:127], v[108:111]
    v_mfma_f32_16x16x32_bf16 v[112:115], a[52:55], a[124:127], v[112:115]
    v_add_f32 v84, v8, v84
    v_add_f32 v85, v9, v85
    v_mfma_f32_16x16x32_bf16 v[116:119], a[56:59], a[124:127], v[116:119]
    ds_read_b128 a[124:127], v3 offset:41728
    v_add_f32 v86, v10, v86
    v_add_f32 v87, v11, v87
    s_waitcnt vmcnt(3)
    s_waitcnt lgkmcnt(3)
    v_mfma_f32_16x16x32_bf16 v[60:63], a[16:19], a[112:115], v[60:63]
    buffer_load_dwordx4 a[48:51], v1, s[8:11], s25 offen offset:0
    v_mfma_f32_16x16x32_bf16 v[64:67], a[20:23], a[112:115], v[64:67]
    v_mfma_f32_16x16x32_bf16 v[68:71], a[24:27], a[112:115], v[68:71]
    ds_read_b128 a[112:115], v3 offset:512
    buffer_load_dwordx4 a[52:55], v1, s[8:11], s25 offen offset:1024
    s_waitcnt lgkmcnt(3)
    v_mfma_f32_16x16x32_bf16 v[76:79], a[16:19], a[116:119], v[76:79]
    v_mfma_f32_16x16x32_bf16 v[80:83], a[20:23], a[116:119], v[80:83]
    buffer_load_dwordx4 a[56:59], v1, s[8:11], s25 offen offset:2048
    v_mfma_f32_16x16x32_bf16 v[84:87], a[24:27], a[116:119], v[84:87]
    ds_read_b128 a[116:119], v3 offset:14336
    s_waitcnt lgkmcnt(3)
    v_mfma_f32_16x16x32_bf16 v[92:95], a[64:67], a[120:123], v[92:95]
    s_add_u32 s25, s25, 26624
    v_mfma_f32_16x16x32_bf16 v[96:99], a[68:71], a[120:123], v[96:99]
    v_mfma_f32_16x16x32_bf16 v[100:103], a[72:75], a[120:123], v[100:103]
    ds_read_b128 a[120:123], v3 offset:27968
    s_waitcnt lgkmcnt(3)
    v_mfma_f32_16x16x32_bf16 v[108:111], a[64:67], a[124:127], v[108:111]
    v_mfma_f32_16x16x32_bf16 v[112:115], a[68:71], a[124:127], v[112:115]
    v_mfma_f32_16x16x32_bf16 v[116:119], a[72:75], a[124:127], v[116:119]
    ds_read_b128 a[124:127], v3 offset:41792
    s_waitcnt vmcnt(3)
    s_waitcnt lgkmcnt(3)
    v_mfma_f32_16x16x32_bf16 v[60:63], a[32:35], a[112:115], v[60:63]
    buffer_load_dwordx4 a[64:67], v1, s[8:11], s25 offen offset:0
    v_mfma_f32_16x16x32_bf16 v[64:67], a[36:39], a[112:115], v[64:67]
    v_mfma_f32_16x16x32_bf16 v[68:71], a[40:43], a[112:115], v[68:71]
    ds_read_b128 a[112:115], v3 offset:576
    buffer_load_dwordx4 a[68:71], v1, s[8:11], s25 offen offset:1024
    s_waitcnt lgkmcnt(3)
    v_mfma_f32_16x16x32_bf16 v[76:79], a[32:35], a[116:119], v[76:79]
    v_mfma_f32_16x16x32_bf16 v[80:83], a[36:39], a[116:119], v[80:83]
    buffer_load_dwordx4 a[72:75], v1, s[8:11], s25 offen offset:2048
    v_mfma_f32_16x16x32_bf16 v[84:87], a[40:43], a[116:119], v[84:87]
    ds_read_b128 a[116:119], v3 offset:14400
    s_waitcnt lgkmcnt(3)
    v_mfma_f32_16x16x32_bf16 v[92:95], a[80:83], a[120:123], v[92:95]
    s_add_u32 s25, s25, 26624
    v_mfma_f32_16x16x32_bf16 v[96:99], a[84:87], a[120:123], v[96:99]
    v_mfma_f32_16x16x32_bf16 v[100:103], a[88:91], a[120:123], v[100:103]
    ds_read_b128 a[120:123], v3 offset:28032
    s_waitcnt lgkmcnt(3)
    v_mfma_f32_16x16x32_bf16 v[108:111], a[80:83], a[124:127], v[108:111]
    v_mfma_f32_16x16x32_bf16 v[112:115], a[84:87], a[124:127], v[112:115]
    v_mfma_f32_16x16x32_bf16 v[116:119], a[88:91], a[124:127], v[116:119]
    ds_read_b128 a[124:127], v3 offset:41856
    s_waitcnt vmcnt(3)
    s_waitcnt lgkmcnt(3)
    v_mfma_f32_16x16x32_bf16 v[60:63], a[48:51], a[112:115], v[60:63]
    buffer_load_dwordx4 a[80:83], v1, s[8:11], s25 offen offset:0
    v_mfma_f32_16x16x32_bf16 v[64:67], a[52:55], a[112:115], v[64:67]
    v_mfma_f32_16x16x32_bf16 v[68:71], a[56:59], a[112:115], v[68:71]
    ds_read_b128 a[112:115], v3 offset:640
    buffer_load_dwordx4 a[84:87], v1, s[8:11], s25 offen offset:1024
    s_waitcnt lgkmcnt(3)
    v_mfma_f32_16x16x32_bf16 v[76:79], a[48:51], a[116:119], v[76:79]
    v_mfma_f32_16x16x32_bf16 v[80:83], a[52:55], a[116:119], v[80:83]
    buffer_load_dwordx4 a[88:91], v1, s[8:11], s25 offen offset:2048
    v_mfma_f32_16x16x32_bf16 v[84:87], a[56:59], a[116:119], v[84:87]
    ds_read_b128 a[116:119], v3 offset:14464
    s_waitcnt lgkmcnt(3)
    v_mfma_f32_16x16x32_bf16 v[92:95], a[0:3], a[120:123], v[92:95]
    s_add_u32 s25, s25, 26624
    v_mfma_f32_16x16x32_bf16 v[96:99], a[4:7], a[120:123], v[96:99]
    v_mfma_f32_16x16x32_bf16 v[100:103], a[8:11], a[120:123], v[100:103]
    ds_read_b128 a[120:123], v3 offset:28096
    s_waitcnt lgkmcnt(3)
    v_mfma_f32_16x16x32_bf16 v[108:111], a[0:3], a[124:127], v[108:111]
    v_mfma_f32_16x16x32_bf16 v[112:115], a[4:7], a[124:127], v[112:115]
    v_mfma_f32_16x16x32_bf16 v[116:119], a[8:11], a[124:127], v[116:119]
    ds_read_b128 a[124:127], v3 offset:41920
    s_waitcnt vmcnt(3)
    s_waitcnt lgkmcnt(3)
    v_mfma_f32_16x16x32_bf16 v[60:63], a[64:67], a[112:115], v[60:63]
    buffer_load_dwordx4 a[96:99], v1, s[8:11], s25 offen offset:0
    v_mfma_f32_16x16x32_bf16 v[64:67], a[68:71], a[112:115], v[64:67]
    buffer_load_dwordx4 a[100:103], v1, s[8:11], s25 offen offset:1024
    v_mfma_f32_16x16x32_bf16 v[68:71], a[72:75], a[112:115], v[68:71]
    ds_read_b128 a[112:115], v3 offset:704
    buffer_load_dwordx4 a[104:107], v1, s[8:11], s25 offen offset:2048
    s_waitcnt lgkmcnt(3)
    v_mfma_f32_16x16x32_bf16 v[76:79], a[64:67], a[116:119], v[76:79]
    s_add_u32 s25, s25, 26624
    v_mfma_f32_16x16x32_bf16 v[80:83], a[68:71], a[116:119], v[80:83]
    v_xor_b32 v6, 0x400, v6
    v_mfma_f32_16x16x32_bf16 v[84:87], a[72:75], a[116:119], v[84:87]
    ds_read_b128 a[116:119], v3 offset:14528
    s_xor_b32 s52, s52, 0x400
    s_waitcnt lgkmcnt(3)
    v_mfma_f32_16x16x32_bf16 v[92:95], a[16:19], a[120:123], v[92:95]
    s_add_u32 m0, s52, 57344
    v_mfma_f32_16x16x32_bf16 v[96:99], a[20:23], a[120:123], v[96:99]
    s_cmp_eq_u32 s24, 7
    s_cbranch_scc0 L_nb30
    v_lshlrev_b32 v8, 4, v0
    v_and_b32 v8, 0x3ff, v8
    s_mov_b64 exec, s[36:37]
    buffer_load_dwordx4 v8, s[20:23], s43 offen lds
    s_mov_b64 exec, -1
L_nb30:
    v_mfma_f32_16x16x32_bf16 v[100:103], a[24:27], a[120:123], v[100:103]
    ds_read_b128 a[120:123], v3 offset:28160
    s_add_u32 s43, s43, 832
    s_waitcnt lgkmcnt(3)
    v_mfma_f32_16x16x32_bf16 v[108:111], a[16:19], a[124:127], v[108:111]
    v_mfma_f32_16x16x32_bf16 v[112:115], a[20:23], a[124:127], v[112:115]
    v_mfma_f32_16x16x32_bf16 v[116:119], a[24:27], a[124:127], v[116:119]
    ds_read_b128 a[124:127], v3 offset:41984
    s_waitcnt vmcnt(3)
    s_waitcnt lgkmcnt(3)
    v_mfma_f32_16x16x32_bf16 v[60:63], a[80:83], a[112:115], v[60:63]
    buffer_load_dwordx4 a[0:3], v1, s[8:11], s25 offen offset:0
    v_mfma_f32_16x16x32_bf16 v[64:67], a[84:87], a[112:115], v[64:67]
    v_mfma_f32_16x16x32_bf16 v[68:71], a[88:91], a[112:115], v[68:71]
    ds_read_b128 a[112:115], v3 offset:768
    buffer_load_dwordx4 a[4:7], v1, s[8:11], s25 offen offset:1024
    s_waitcnt lgkmcnt(3)
    v_mfma_f32_16x16x32_bf16 v[76:79], a[80:83], a[116:119], v[76:79]
    v_mfma_f32_16x16x32_bf16 v[80:83], a[84:87], a[116:119], v[80:83]
    buffer_load_dwordx4 a[8:11], v1, s[8:11], s25 offen offset:2048
    v_mfma_f32_16x16x32_bf16 v[84:87], a[88:91], a[116:119], v[84:87]
    ds_read_b128 a[116:119], v3 offset:14592
    s_waitcnt lgkmcnt(3)
    v_mfma_f32_16x16x32_bf16 v[92:95], a[32:35], a[120:123], v[92:95]
    s_add_u32 s25, s25, 26624
    v_mfma_f32_16x16x32_bf16 v[96:99], a[36:39], a[120:123], v[96:99]
    v_mfma_f32_16x16x32_bf16 v[100:103], a[40:43], a[120:123], v[100:103]
    ds_read_b128 a[120:123], v3 offset:28224
    s_waitcnt lgkmcnt(3)
    v_mfma_f32_16x16x32_bf16 v[108:111], a[32:35], a[124:127], v[108:111]
    v_mfma_f32_16x16x32_bf16 v[112:115], a[36:39], a[124:127], v[112:115]
    v_mfma_f32_16x16x32_bf16 v[116:119], a[40:43], a[124:127], v[116:119]
    ds_read_b128 a[124:127], v3 offset:42048
    s_waitcnt vmcnt(3)
    s_waitcnt lgkmcnt(3)
    v_mfma_f32_16x16x32_bf16 v[60:63], a[96:99], a[112:115], v[60:63]
    buffer_load_dwordx4 a[16:19], v1, s[8:11], s25 offen offset:0
    v_mfma_f32_16x16x32_bf16 v[64:67], a[100:103], a[112:115], v[64:67]
    v_mfma_f32_16x16x32_bf16 v[68:71], a[104:107], a[112:115], v[68:71]
    buffer_load_dwordx4 a[20:23], v1, s[8:11], s25 offen offset:1024
    s_waitcnt lgkmcnt(2)
    v_mfma_f32_16x16x32_bf16 v[76:79], a[96:99], a[116:119], v[76:79]
    v_mfma_f32_16x16x32_bf16 v[80:83], a[100:103], a[116:119], v[80:83]
    buffer_load_dwordx4 a[24:27], v1, s[8:11], s25 offen offset:2048
    v_mfma_f32_16x16x32_bf16 v[84:87], a[104:107], a[116:119], v[84:87]
    s_waitcnt lgkmcnt(1)
    v_mfma_f32_16x16x32_bf16 v[92:95], a[48:51], a[120:123], v[92:95]
    s_add_u32 s25, s25, 26624
    v_lshlrev_b32 v12, 16, v28
    v_and_b32 v13, 0xffff0000, v28
    v_lshlrev_b32 v14, 16, v29
    v_and_b32 v15, 0xffff0000, v29
    v_mfma_f32_16x16x32_bf16 v[96:99], a[52:55], a[120:123], v[96:99]
    v_lshlrev_b32 v16, 16, v30
    v_and_b32 v17, 0xffff0000, v30
    v_lshlrev_b32 v18, 16, v31
    v_and_b32 v19, 0xffff0000, v31
    v_mfma_f32_16x16x32_bf16 v[100:103], a[56:59], a[120:123], v[100:103]
    ds_read_b128 a[120:123], v3 offset:28288
    v_mul_f32 v12, v60, v12
    v_mul_f32 v13, v61, v13
    v_mul_f32 v14, v62, v14
    v_mul_f32 v15, v63, v15
    s_waitcnt lgkmcnt(1)
    v_mfma_f32_16x16x32_bf16 v[108:111], a[48:51], a[124:127], v[108:111]
    v_mul_f32 v16, v64, v16
    v_mul_f32 v17, v65, v17
    v_mul_f32 v18, v66, v18
    v_mul_f32 v19, v67, v19
    v_mfma_f32_16x16x32_bf16 v[112:115], a[52:55], a[124:127], v[112:115]
    v_cvt_pk_bf16_f32 v8, v12, v13
    v_cvt_pk_bf16_f32 v9, v14, v15
    v_cvt_pk_bf16_f32 v10, v16, v17
    v_cvt_pk_bf16_f32 v11, v18, v19
    v_mfma_f32_16x16x32_bf16 v[116:119], a[56:59], a[124:127], v[116:119]
    ds_read_b128 a[124:127], v3 offset:42112
    s_nop 1
    v_permlane16_swap_b32 v8, v10
    v_permlane16_swap_b32 v9, v11
    ds_write_b128 v4, v[8:11] offset:0
    s_waitcnt lgkmcnt(2)
    v_mfma_f32_16x16x32_bf16 v[92:95], a[64:67], a[120:123], v[92:95]
    buffer_load_dwordx4 a[32:35], v1, s[8:11], s25 offen offset:0
    v_mfma_f32_16x16x32_bf16 v[96:99], a[68:71], a[120:123], v[96:99]
    buffer_load_dwordx4 a[36:39], v1, s[8:11], s25 offen offset:1024
    v_lshlrev_b32 v12, 16, v36
    v_and_b32 v13, 0xffff0000, v36
    v_lshlrev_b32 v14, 16, v37
    v_and_b32 v15, 0xffff0000, v37
    v_lshlrev_b32 v16, 16, v38
    v_mfma_f32_16x16x32_bf16 v[100:103], a[72:75], a[120:123], v[100:103]
    ds_read_b128 a[120:123], v3 offset:28352
    buffer_load_dwordx4 a[40:43], v1, s[8:11], s25 offen offset:2048
    v_and_b32 v17, 0xffff0000, v38
    v_lshlrev_b32 v18, 16, v39
    v_and_b32 v19, 0xffff0000, v39
    v_mul_f32 v12, v76, v12
    v_mul_f32 v13, v77, v13
    s_waitcnt lgkmcnt(2)
    v_mfma_f32_16x16x32_bf16 v[108:111], a[64:67], a[124:127], v[108:111]
    s_add_u32 s25, s25, 26624
    v_mul_f32 v14, v78, v14
    v_mul_f32 v15, v79, v15
    v_mul_f32 v16, v80, v16
    v_mul_f32 v17, v81, v17
    v_mul_f32 v18, v82, v18
    v_mfma_f32_16x16x32_bf16 v[112:115], a[68:71], a[124:127], v[112:115]
    v_mul_f32 v19, v83, v19
    v_cvt_pk_bf16_f32 v8, v12, v13
    v_cvt_pk_bf16_f32 v9, v14, v15
    v_cvt_pk_bf16_f32 v10, v16, v17
    v_mfma_f32_16x16x32_bf16 v[116:119], a[72:75], a[124:127], v[116:119]
    ds_read_b128 a[124:127], v3 offset:42176
    v_cvt_pk_bf16_f32 v11, v18, v19
    s_nop 1
    v_permlane16_swap_b32 v8, v10
    v_permlane16_swap_b32 v9, v11
    ds_write_b128 v4, v[8:11] offset:13824
    s_waitcnt lgkmcnt(2)
    v_mfma_f32_16x16x32_bf16 v[92:95], a[80:83], a[120:123], v[92:95]
    v_mfma_f32_16x16x32_bf16 v[96:99], a[84:87], a[120:123], v[96:99]
    v_lshlrev_b32 v12, 16, v32
    v_and_b32 v13, 0xffff0000, v32
    v_lshlrev_b32 v14, 16, v33
    v_and_b32 v15, 0xffff0000, v33
    v_lshlrev_b32 v16, 16, v40
    v_mfma_f32_16x16x32_bf16 v[100:103], a[88:91], a[120:123], v[100:103]
    ds_read_b128 a[120:123], v3 offset:28416
    v_and_b32 v17, 0xffff0000, v40
    v_lshlrev_b32 v18, 16, v41
    v_and_b32 v19, 0xffff0000, v41
    v_mul_f32 v12, v68, v12
    v_mul_f32 v13, v69, v13
    s_waitcnt lgkmcnt(2)
    v_mfma_f32_16x16x32_bf16 v[108:111], a[80:83], a[124:127], v[108:111]
    v_mul_f32 v14, v70, v14
    v_mul_f32 v15, v71, v15
    v_mul_f32 v16, v84, v16
    v_mul_f32 v17, v85, v17
    v_mul_f32 v18, v86, v18
    v_mfma_f32_16x16x32_bf16 v[112:115], a[84:87], a[124:127], v[112:115]
    v_mul_f32 v19, v87, v19
    v_cvt_pk_bf16_f32 v8, v12, v13
    v_cvt_pk_bf16_f32 v9, v14, v15
    v_cvt_pk_bf16_f32 v10, v16, v17
    v_mfma_f32_16x16x32_bf16 v[116:119], a[88:91], a[124:127], v[116:119]
    ds_read_b128 a[124:127], v3 offset:42240
    v_cvt_pk_bf16_f32 v11, v18, v19
    s_nop 1
    v_permlane16_swap_b32 v8, v10
    v_permlane16_swap_b32 v9, v11
    ds_write_b128 v5, v[8:11] offset:0
    s_waitcnt lgkmcnt(0)
    s_barrier
    v_xor_b32 v3, 65536, v3
    v_mfma_f32_16x16x32_bf16 v[92:95], a[96:99], a[120:123], v[92:95]
    ds_read_b128 a[112:115], v3 offset:0
    ds_read_b128 a[116:119], v3 offset:13824
    v_mfma_f32_16x16x32_bf16 v[96:99], a[100:103], a[120:123], v[96:99]
    buffer_load_dwordx4 a[48:51], v1, s[8:11], s25 offen offset:0
    v_mfma_f32_16x16x32_bf16 v[100:103], a[104:107], a[120:123], v[100:103]
    buffer_load_dwordx4 a[52:55], v1, s[8:11], s25 offen offset:1024
    buffer_load_dwordx4 a[56:59], v1, s[8:11], s25 offen offset:2048
    v_mfma_f32_16x16x32_bf16 v[108:111], a[96:99], a[124:127], v[108:111]
    s_add_u32 s25, s25, 26624
    v_mfma_f32_16x16x32_bf16 v[112:115], a[100:103], a[124:127], v[112:115]
    v_mfma_f32_16x16x32_bf16 v[116:119], a[104:107], a[124:127], v[116:119]
    v_lshlrev_b32 v12, 16, v44
    v_and_b32 v13, 0xffff0000, v44
    v_lshlrev_b32 v14, 16, v45
    v_and_b32 v15, 0xffff0000, v45
    v_lshlrev_b32 v16, 16, v46
    v_and_b32 v17, 0xffff0000, v46
    v_lshlrev_b32 v18, 16, v47
    v_and_b32 v19, 0xffff0000, v47
    v_mul_f32 v12, v92, v12
    v_mul_f32 v13, v93, v13
    v_mul_f32 v14, v94, v14
    v_mul_f32 v15, v95, v15
    v_mul_f32 v16, v96, v16
    v_mul_f32 v17, v97, v17
    v_mul_f32 v18, v98, v18
    v_mul_f32 v19, v99, v19
    v_cvt_pk_bf16_f32 v8, v12, v13
    v_cvt_pk_bf16_f32 v9, v14, v15
    v_cvt_pk_bf16_f32 v10, v16, v17
    v_cvt_pk_bf16_f32 v11, v18, v19
    s_nop 1
    v_permlane16_swap_b32 v8, v10
    v_permlane16_swap_b32 v9, v11
    ds_write_b128 v4, v[8:11] offset:27648
    s_add_u32 s28, s28, 1
    s_cmp_lt_u32 s28, 6
    s_waitcnt lgkmcnt(0)
    s_cbranch_scc1 L_layer3
    s_nop 7
    v_lshlrev_b32 v12, 16, v52
    v_and_b32 v13, 0xffff0000, v52
    v_lshlrev_b32 v14, 16, v53
    v_and_b32 v15, 0xffff0000, v53
    v_lshlrev_b32 v16, 16, v54
    v_and_b32 v17, 0xffff0000, v54
    v_lshlrev_b32 v18, 16, v55
    v_and_b32 v19, 0xffff0000, v55
    v_mul_f32 v12, v108, v12
    v_mul_f32 v13, v109, v13
    v_mul_f32 v14, v110, v14
    v_mul_f32 v15, v111, v15
    v_mul_f32 v16, v112, v16
    v_mul_f32 v17, v113, v17
    v_mul_f32 v18, v114, v18
    v_mul_f32 v19, v115, v19
    v_cvt_pk_bf16_f32 v8, v12, v13
    v_cvt_pk_bf16_f32 v9, v14, v15
    v_cvt_pk_bf16_f32 v10, v16, v17
    v_cvt_pk_bf16_f32 v11, v18, v19
    s_nop 1
    v_permlane16_swap_b32 v8, v10
    v_permlane16_swap_b32 v9, v11
    ds_write_b128 v4, v[8:11] offset:41472
    v_lshlrev_b32 v12, 16, v48
    v_and_b32 v13, 0xffff0000, v48
    v_lshlrev_b32 v14, 16, v49
    v_and_b32 v15, 0xffff0000, v49
    v_lshlrev_b32 v16, 16, v56
    v_and_b32 v17, 0xffff0000, v56
    v_lshlrev_b32 v18, 16, v57
    v_and_b32 v19, 0xffff0000, v57
    v_mul_f32 v12, v100, v12
    v_mul_f32 v13, v101, v13
    v_mul_f32 v14, v102, v14
    v_mul_f32 v15, v103, v15
    v_mul_f32 v16, v116, v16
    v_mul_f32 v17, v117, v17
    v_mul_f32 v18, v118, v18
    v_mul_f32 v19, v119, v19
    v_cvt_pk_bf16_f32 v8, v12, v13
    v_cvt_pk_bf16_f32 v9, v14, v15
    v_cvt_pk_bf16_f32 v10, v16, v17
    v_cvt_pk_bf16_f32 v11, v18, v19
    s_nop 1
    v_permlane16_swap_b32 v8, v10
    v_permlane16_swap_b32 v9, v11
    ds_write_b128 v5, v[8:11] offset:27648
    s_branch L_fin
L_fin:
    s_waitcnt lgkmcnt(0)
    s_barrier
    v_and_b32 v49, 63, v0
    v_lshlrev_b32 v50, 4, v49
    v_xor_b32 v51, 16, v50
    s_mul_i32 s38, s24, 6656
    s_mul_i32 s39, s24, 6912
    v_add_u32 v48, s39, v50
    s_mov_b64 exec, s[36:37]
    ds_read_b128 v[56:59], v48 offset:0
    ds_read_b128 v[60:63], v48 offset:864
    ds_read_b128 v[64:67], v48 offset:1728
    ds_read_b128 v[68:71], v48 offset:2592
    ds_read_b128 v[72:75], v48 offset:3456
    ds_read_b128 v[76:79], v48 offset:4320
    ds_read_b128 v[80:83], v48 offset:5184
    ds_read_b128 v[84:87], v48 offset:6048
    s_waitcnt lgkmcnt(7)
    buffer_store_dwordx4 v[56:59], v50, s[16:19], s38 offen nt
    s_add_u32 s38, s38, 832
    s_waitcnt lgkmcnt(6)
    buffer_store_dwordx4 v[60:63], v50, s[16:19], s38 offen nt
    s_add_u32 s38, s38, 832
    s_waitcnt lgkmcnt(5)
    buffer_store_dwordx4 v[64:67], v50, s[16:19], s38 offen nt
    s_add_u32 s38, s38, 832
    s_waitcnt lgkmcnt(4)
    buffer_store_dwordx4 v[68:71], v50, s[16:19], s38 offen nt
    s_add_u32 s38, s38, 832
    s_waitcnt lgkmcnt(3)
    buffer_store_dwordx4 v[72:75], v51, s[16:19], s38 offen nt
    s_add_u32 s38, s38, 832
    s_waitcnt lgkmcnt(2)
    buffer_store_dwordx4 v[76:79], v51, s[16:19], s38 offen nt
    s_add_u32 s38, s38, 832
    s_waitcnt lgkmcnt(1)
    buffer_store_dwordx4 v[80:83], v51, s[16:19], s38 offen nt
    s_add_u32 s38, s38, 832
    s_waitcnt lgkmcnt(0)
    buffer_store_dwordx4 v[84:87], v51, s[16:19], s38 offen nt
    s_add_u32 s38, s38, 832
L_done:
s_endpgm
.section .rodata,"a"
.p2align 6
.amdhsa_kernel dcn_pre_kernel
  .amdhsa_next_free_vgpr 64
  .amdhsa_next_free_sgpr 102
  .amdhsa_accum_offset 64
  .amdhsa_group_segment_fixed_size 0
  .amdhsa_kernarg_size 48
  .amdhsa_user_sgpr_count 2
  .amdhsa_user_sgpr_kernarg_segment_ptr 1
  .amdhsa_system_sgpr_workgroup_id_x 1
.end_amdhsa_kernel
.p2align 6
.amdhsa_kernel standalone__cross_network_dcn__recsys_kernel
  .amdhsa_next_free_vgpr 252
  .amdhsa_next_free_sgpr 102
  .amdhsa_accum_offset 124
  .amdhsa_group_segment_fixed_size 0
  .amdhsa_kernarg_size 48
  .amdhsa_user_sgpr_count 2
  .amdhsa_user_sgpr_kernarg_segment_ptr 1
  .amdhsa_system_sgpr_workgroup_id_x 1
.end_amdhsa_kernel
```
